```python
import torch

def _softmax(x, axis=-1):
    return torch.softmax(x, dim=axis)
def _gelu(x):
    return torch.nn.functional.gelu(x, approximate="tanh")
def _silu(x):
    return torch.nn.functional.silu(x)
def _sigmoid(x):
    return torch.sigmoid(x)
def _layernorm(x, axis=-1, eps=1e-5):
    m = x.mean(dim=axis, keepdim=True)
    v = x.var(dim=axis, keepdim=True, unbiased=False)
    return (x - m) / torch.sqrt(v + eps)
def _scatter_add(tgt, idx, src, axis=0):
    return tgt.clone().index_add_(axis, idx, src)
def _segment_sum(src, seg, n):
    out = torch.zeros((n,) + src.shape[1:], dtype=src.dtype)
    return out.index_add_(0, seg, src)
def _pad(x, pw):
    flat = tuple(v for pair in reversed(pw) for v in pair)
    return torch.nn.functional.pad(x, flat)

kernel_name = 'sequential_preLN__sliding_block_cached__mixer_token_mlp__decode'

def setup_inputs():

    _w = (lambda a: (lambda t: t.to(torch.bfloat16) if t.is_floating_point() else t)(torch.as_tensor(a)))
    def _A_setup():
        B, Sq, D = 4, 1, 448
        Hq, Hkv, Sk, Dh = 16, 8, 8192, 256
        assert Hq % Hkv == 0, (Hq, Hkv)
        return {
            "x": _w((lambda *s: torch.randn(*s, dtype=torch.bfloat16) * 0.05)(B, Sq, D)),
            "k_cache": _w((lambda *s: torch.randn(*s, dtype=torch.bfloat16) * 1.6)(B, Hkv, Sk, Dh)),
            "v_cache": _w((lambda *s: torch.randn(*s, dtype=torch.bfloat16) * 0.4)(B, Hkv, Sk, Dh)),
            "wq": _w((lambda *s: torch.randn(*s, dtype=torch.bfloat16) * 1.6)(D, Hq * Dh) * (D ** -0.5)),
            "wo": _w((lambda *s: torch.randn(*s, dtype=torch.bfloat16) * 0.4)(Hq * Dh, D) * ((Hq * Dh) ** -0.5)),
        }
    _A_in = _A_setup()

    def _B_setup():
        B, S, D, F = 4, 1, 448, 1792
        return {
            "x": _w((lambda *s: torch.randn(*s, dtype=torch.bfloat16) * 0.05)(B, S, D)),
            "w1": _w((lambda *s: torch.randn(*s, dtype=torch.bfloat16) * 1.6)(S, F) * (S ** -0.5)),
            "b1": _w((lambda *s: torch.randn(*s, dtype=torch.bfloat16) * 1.6)(F) * 0.02),
            "w2": _w((lambda *s: torch.randn(*s, dtype=torch.bfloat16) * 0.1)(F, S) * (F ** -0.5)),
            "b2": _w((lambda *s: torch.randn(*s, dtype=torch.bfloat16) * 0.1)(S) * 0.02),
        }
    _B_in = _B_setup()

    return {
        "A_x": _A_in["x"],
        "A_k_cache": _A_in["k_cache"],
        "A_v_cache": _A_in["v_cache"],
        "A_wq": _A_in["wq"],
        "A_wo": _A_in["wo"],
        "B_x": _B_in["x"],
        "B_w1": _B_in["w1"],
        "B_b1": _B_in["b1"],
        "B_w2": _B_in["w2"],
        "B_b2": _B_in["b2"],
    }

def reference(A_x, A_k_cache, A_v_cache, A_wq, A_wo, B_x, B_w1, B_b1, B_w2, B_b2):
    def _A_ref(x, k_cache, v_cache, wq, wo):
        B, Sq, D = x.shape
        Hq, Dh = 16, 256
        Hkv, Sk = k_cache.shape[1], k_cache.shape[2]
        W = min(4096, max(256, Sk // 4))
        rep = Hq // Hkv
        q = (lambda x, *d: x.permute(*d))((x @ wq).reshape(B, Sq, Hq, Dh), 0, 2, 1, 3)
        k = (lambda x, n, axis: torch.repeat_interleave(x, n, dim=axis))(k_cache[:, :, Sk - W:, :], rep, axis=1)
        v = (lambda x, n, axis: torch.repeat_interleave(x, n, dim=axis))(v_cache[:, :, Sk - W:, :], rep, axis=1)
        scores = torch.einsum("bhqd,bhkd->bhqk", q, k) * (Dh ** -0.5)
        p = _softmax(scores, axis=-1)
        o = torch.einsum("bhqk,bhkd->bhqd", p, v)
        return (lambda x, *d: x.permute(*d))(o, 0, 2, 1, 3).reshape(B, Sq, Hq * Dh) @ wo

    def _B_ref(x, w1, b1, w2, b2):
        B, S, D = x.shape
        h = _layernorm(x, axis=-1)
        u = torch.einsum("bsd,sf->bdf", h, w1) + b1
        u = _gelu(u)
        y = torch.einsum("bdf,fs->bds", u, w2) + b2
        return (lambda x, *d: x.permute(*d))(y, 0, 2, 1)

    x = A_x
    h = x + _A_ref(_layernorm(x, axis=-1), A_k_cache, A_v_cache, A_wq, A_wo)
    h2 = h + _B_ref(_layernorm(h, axis=-1), B_w1, B_b1, B_w2, B_b2)
    return h2
```

```asm
; @launch grid=(256,1,1) block=(768,1,1) lds=88064
.amdgcn_target "amdgcn-amd-amdhsa--gfx950"
.text
.globl sequential_preLN__sliding_block_cached__mixer_token_mlp__decode_kernel
.p2align 8
.type sequential_preLN__sliding_block_cached__mixer_token_mlp__decode_kernel,@function
sequential_preLN__sliding_block_cached__mixer_token_mlp__decode_kernel:
    s_cmp_ge_u32 s2, 256
    s_cbranch_scc1 L_end
    s_load_dwordx16 s[4:19], s[0:1], 0
    s_load_dwordx8 s[20:27], s[0:1], 64
    s_load_dwordx2 s[28:29], s[0:1], 96
    v_lshrrev_b32 v2, 6, v0
    v_and_b32 v1, 63, v0
    s_setprio 3
    v_readfirstlane_b32 s30, v2
    s_cmp_ge_u32 s30, 4
    s_cbranch_scc1 L_stream
    s_cmp_eq_u32 s30, 0
    s_cbranch_scc1 L_qwave
    s_and_b32 s31, s2, 7
    s_lshr_b32 s33, s2, 3
    s_lshr_b32 s32, s2, 6
    s_add_u32 s33, s33, s32
    s_and_b32 s33, s33, 7
    s_lshl3_add_u32 s34, s32, s31
    s_lshl3_add_u32 s35, s34, s33
    s_sub_u32 s30, s30, 1
    v_lshrrev_b32 v7, 2, v1
    v_lshlrev_b32 v7, 13, v7
    v_and_b32 v8, 3, v1
    v_lshl_add_u32 v7, v8, 4, v7
    v_lshlrev_b32 v9, 4, v1
    s_and_b32 s54, s32, 1
    s_lshl1_add_u32 s54, s33, s54
    s_lshr_b32 s47, s32, 1
    s_lshl4_add_u32 s52, s31, s54
    s_lshl_b32 s52, s52, 6
    s_mul_i32 s53, s47, 1835008
    s_add_u32 s52, s52, s53
    s_mul_i32 s53, s30, 655360
    s_add_u32 s56, s52, s53
    s_mul_i32 s55, s30, 5120
    s_add_u32 m0, s55, 20480
    s_add_u32 s57, s56, 130048
    s_add_u32 s58, s57, 130048
    s_add_u32 s59, s58, 130048
    s_add_u32 s52, s56, 524288
    s_add_u32 s55, s55, 24576
    s_mov_b32 s42, 3670016
    s_mov_b32 s43, 0x20000
    s_mov_b32 s50, 0x20000000
    s_mov_b32 s51, 0x20000
    v_mov_b32 v16, -1
    v_mov_b32 v17, -1
    v_mov_b32 v18, -1
    v_mov_b32 v19, -1
    s_lshl1_add_u32 s53, s35, s30
    s_lshl_b32 s53, s53, 10
    s_add_u32 s53, s53, 524288
    v_add_u32 v10, s53, v9
    s_cmp_lg_u32 s30, 2
    s_cbranch_scc1 L_inv
    s_lshl4_add_u32 s44, s47, s31
    s_and_b32 s45, s32, 1
    s_lshl1_add_u32 s44, s44, s45
    s_lshl3_add_u32 s44, s44, s33
    s_lshl_b32 s44, s44, 8
    s_add_u32 s44, s44, 1572864
    v_bfe_u32 v3, v1, 4, 1
    v_and_b32 v5, 15, v1
    v_lshlrev_b32 v10, 4, v5
    v_lshl_add_u32 v10, v3, 15, v10
    v_add_u32 v10, s44, v10
L_inv:
    s_waitcnt lgkmcnt(0)
    s_mov_b32 s40, s10
    s_mov_b32 s41, s11
    buffer_load_dwordx4 v7, s[40:43], s56 offen offset:0 nt lds
    buffer_load_dwordx4 v7, s[40:43], s57 offen offset:1024 nt lds
    buffer_load_dwordx4 v7, s[40:43], s58 offen offset:2048 nt lds
    buffer_load_dwordx4 v7, s[40:43], s59 offen offset:3072 nt lds
    s_mov_b32 m0, s55
    s_mov_b32 s48, s28
    s_mov_b32 s49, s29
    s_cmp_eq_u32 s30, 2
    s_cbranch_scc1 L_wq4
    buffer_load_dwordx4 v7, s[40:43], s52 offen nt lds
L_wq4:
    buffer_store_dwordx4 v[16:19], v10, s[48:51], 0 offen sc1
    s_cselect_b32 s36, s20, s18
    s_cselect_b32 s37, s21, s19
    s_cmp_eq_u32 s30, 0
    s_cselect_b32 s36, s16, s36
    s_cselect_b32 s37, s17, s37
    s_lshl_b32 s44, s30, 12
    s_add_u32 m0, s44, 8192
    s_mov_b32 s38, 3584
    s_mov_b32 s39, 0x20000
    s_barrier
    buffer_load_dwordx4 v9, s[36:39], 0 offen offset:0 lds
    buffer_load_dwordx4 v9, s[36:39], 0 offen offset:1024 lds
    buffer_load_dwordx4 v9, s[36:39], 0 offen offset:2048 lds
    buffer_load_dwordx4 v9, s[36:39], 0 offen offset:3072 lds
    s_branch L_helper
L_qwave:
    v_mov_b32 v12, 0
    v_mov_b32 v13, 0
    v_mov_b32 v14, 0
    v_mov_b32 v15, 0
    v_lshlrev_b32 v9, 4, v1
    ds_write_b128 v12, v[12:15] offset:0
    ds_write_b64 v12, v[12:13] offset:16
    s_mov_b32 s38, 3584
    s_mov_b32 s39, 0x20000
    s_mov_b32 m0, 34816
    s_waitcnt lgkmcnt(0)
    s_mov_b32 s36, s4
    s_mov_b32 s37, s5
    buffer_load_dwordx4 v9, s[36:39], 0 offen offset:0 lds
    buffer_load_dwordx4 v9, s[36:39], 0 offen offset:1024 lds
    buffer_load_dwordx4 v9, s[36:39], 0 offen offset:2048 lds
    buffer_load_dwordx4 v9, s[36:39], 0 offen offset:3072 lds
    s_barrier
    s_branch L_qmain
L_stream:
    s_and_b32 s31, s2, 7
    s_lshr_b32 s33, s2, 3
    s_lshr_b32 s32, s2, 6
    s_add_u32 s33, s33, s32
    s_and_b32 s33, s33, 7
    s_lshl3_add_u32 s34, s32, s31
    s_lshl3_add_u32 s35, s34, s33
    s_sub_u32 s30, s30, 4
    s_mov_b32 s52, s32
    s_lshl1_add_u32 s52, s33, s52
    s_add_u32 s52, s52, s30
    s_and_b32 s52, s52, 7
    s_mov_b32 s54, s33
    s_lshl3_add_u32 s52, s33, s52
    s_lshl_b32 s52, s52, 14
    s_lshl_b32 s53, s34, 22
    s_add_u32 s52, s52, s53
    s_add_u32 s52, s52, 3145728
    s_add_u32 s53, s54, 0
    s_and_b32 s53, s53, 7
    s_lshl_b32 s53, s53, 11
    s_add_u32 s66, s52, s53
    v_lshrrev_b32 v2, 4, v1
    v_and_b32 v3, 3, v1
    v_lshlrev_b32 v3, 4, v3
    v_lshl_add_u32 v3, v2, 6, v3
    v_bfe_u32 v4, v1, 2, 2
    v_lshl_add_u32 v14, v4, 9, v3
    s_mov_b32 s38, 0x8000000
    s_mov_b32 s39, 0x20000
    s_setprio 3
    s_waitcnt lgkmcnt(0)
    s_mov_b32 s36, s6
    s_mov_b32 s37, s7
    buffer_load_dwordx4 v[40:43], v14, s[36:39], s66 offen offset:0 nt
    s_add_u32 s53, s54, 1
    s_and_b32 s53, s53, 7
    s_lshl_b32 s53, s53, 11
    s_add_u32 s67, s52, s53
    s_add_u32 s53, s54, 2
    s_and_b32 s53, s53, 7
    s_lshl_b32 s53, s53, 11
    s_add_u32 s68, s52, s53
    s_add_u32 s53, s54, 3
    s_and_b32 s53, s53, 7
    s_lshl_b32 s53, s53, 11
    s_add_u32 s69, s52, s53
    s_add_u32 s53, s54, 4
    s_and_b32 s53, s53, 7
    s_lshl_b32 s53, s53, 11
    s_add_u32 s70, s52, s53
    s_add_u32 s53, s54, 5
    s_and_b32 s53, s53, 7
    s_lshl_b32 s53, s53, 11
    s_add_u32 s71, s52, s53
    s_add_u32 s53, s54, 6
    s_and_b32 s53, s53, 7
    s_lshl_b32 s53, s53, 11
    s_add_u32 s72, s52, s53
    s_add_u32 s53, s54, 7
    s_and_b32 s53, s53, 7
    s_lshl_b32 s53, s53, 11
    s_add_u32 s73, s52, s53
    s_barrier
    .p2align 3
    buffer_load_dwordx4 v[44:47], v14, s[36:39], s66 offen offset:256 nt
    buffer_load_dwordx4 v[48:51], v14, s[36:39], s67 offen offset:0 nt
    buffer_load_dwordx4 v[52:55], v14, s[36:39], s67 offen offset:256 nt
    buffer_load_dwordx4 v[56:59], v14, s[36:39], s68 offen offset:0 nt
    buffer_load_dwordx4 v[60:63], v14, s[36:39], s68 offen offset:256 nt
    buffer_load_dwordx4 v[64:67], v14, s[36:39], s69 offen offset:0 nt
    buffer_load_dwordx4 v[68:71], v14, s[36:39], s69 offen offset:256 nt
    buffer_load_dwordx4 v[72:75], v14, s[36:39], s70 offen offset:0 nt
    buffer_load_dwordx4 v[76:79], v14, s[36:39], s70 offen offset:256 nt
    buffer_load_dwordx4 v[80:83], v14, s[36:39], s71 offen offset:0 nt
    buffer_load_dwordx4 v[84:87], v14, s[36:39], s71 offen offset:256 nt
    buffer_load_dwordx4 v[88:91], v14, s[36:39], s72 offen offset:0 nt
    buffer_load_dwordx4 v[92:95], v14, s[36:39], s72 offen offset:256 nt
    buffer_load_dwordx4 v[96:99], v14, s[36:39], s73 offen offset:0 nt
    buffer_load_dwordx4 v[100:103], v14, s[36:39], s73 offen offset:256 nt
    s_mov_b32 s48, s28
    s_mov_b32 s49, s29
    s_mov_b32 s50, 536870912
    s_mov_b32 s51, 0x20000
    s_mov_b32 s40, s8
    s_mov_b32 s41, s9
    s_mov_b32 s42, 134217728
    s_mov_b32 s43, 0x20000
    v_and_b32 v5, 15, v1
    v_lshlrev_b32 v5, 4, v5
    v_lshl_add_u32 v15, v2, 9, v5
    s_setprio 2
    s_cmp_lt_u32 s30, 4
    s_cbranch_scc1 L_late1
    s_setprio 1
L_late1:
    v_bfe_u32 v4, v1, 3, 1
    v_lshl_add_u32 v39, v4, 9, v3
    v_and_b32 v4, 1, v1
    v_lshlrev_b32 v4, 4, v4
    v_mov_b32 v5, 0xffff
    v_lshlrev_b32 v5, v4, v5
    v_bfe_u32 v4, v1, 1, 2
    v_cmp_eq_u32 vcc, 0, v4
    s_nop 1
    v_cndmask_b32 v10, 0, v5, vcc
    v_cmp_eq_u32 vcc, 1, v4
    s_nop 1
    v_cndmask_b32 v11, 0, v5, vcc
    v_cmp_eq_u32 vcc, 2, v4
    s_nop 1
    v_cndmask_b32 v12, 0, v5, vcc
    v_cmp_eq_u32 vcc, 3, v4
    s_nop 1
    v_cndmask_b32 v13, 0, v5, vcc
    s_mov_b32 s61, 0x3db8aa3b
    v_mov_b32 v33, 0
    .p2align 3
    buffer_load_dwordx4 v[104:107], v15, s[40:43], s66 offen offset:0 nt
    buffer_load_dwordx4 v[108:111], v15, s[40:43], s66 offen offset:256 nt
    buffer_load_dwordx4 v[112:115], v15, s[40:43], s67 offen offset:0 nt
    buffer_load_dwordx4 v[116:119], v15, s[40:43], s67 offen offset:256 nt
    buffer_load_dwordx4 v[120:123], v15, s[40:43], s68 offen offset:0 nt
    buffer_load_dwordx4 v[124:127], v15, s[40:43], s68 offen offset:256 nt
    buffer_load_dwordx4 v[128:131], v15, s[40:43], s69 offen offset:0 nt
    buffer_load_dwordx4 v[132:135], v15, s[40:43], s69 offen offset:256 nt
    buffer_load_dwordx4 v[136:139], v15, s[40:43], s70 offen offset:0 nt
    buffer_load_dwordx4 v[140:143], v15, s[40:43], s70 offen offset:256 nt
    buffer_load_dwordx4 v[144:147], v15, s[40:43], s71 offen offset:0 nt
    buffer_load_dwordx4 v[148:151], v15, s[40:43], s71 offen offset:256 nt
    buffer_load_dwordx4 v[152:155], v15, s[40:43], s72 offen offset:0 nt
    buffer_load_dwordx4 v[156:159], v15, s[40:43], s72 offen offset:256 nt
    buffer_load_dwordx4 v[160:163], v15, s[40:43], s73 offen offset:0 nt
    buffer_load_dwordx4 v[164:167], v15, s[40:43], s73 offen offset:256 nt
    s_setprio 3
    s_mov_b32 s60, 0
    s_branch L_qwf_1
L_qw_2:
    s_sleep 2
L_qwf_1:
    ds_read_b32 v34, v33 offset:0
    s_waitcnt lgkmcnt(0)
    v_cmp_eq_u32 vcc, 0, v34
    s_cbranch_vccz L_out_3
    s_add_u32 s60, s60, 1
    s_cmp_le_u32 s60, 200000
    s_cbranch_scc1 L_qw_2
L_out_3:
    ds_read_b128 v[2:5], v39 offset:256
    ds_read_b128 v[6:9], v39 offset:512
    v_readfirstlane_b32 s59, v34
    s_waitcnt vmcnt(16) lgkmcnt(0)
    v_mfma_f32_16x16x32_bf16 v[16:19], v[40:43], v[2:5], 0
    v_mfma_f32_16x16x32_bf16 v[16:19], v[44:47], v[6:9], v[16:19]
    v_mfma_f32_16x16x32_bf16 v[40:43], v[48:51], v[2:5], 0
    v_mfma_f32_16x16x32_bf16 v[40:43], v[52:55], v[6:9], v[40:43]
    v_mfma_f32_16x16x32_bf16 v[48:51], v[56:59], v[2:5], 0
    v_mfma_f32_16x16x32_bf16 v[48:51], v[60:63], v[6:9], v[48:51]
    v_mfma_f32_16x16x32_bf16 v[56:59], v[64:67], v[2:5], 0
    v_mfma_f32_16x16x32_bf16 v[56:59], v[68:71], v[6:9], v[56:59]
    v_mfma_f32_16x16x32_bf16 v[64:67], v[72:75], v[2:5], 0
    v_mfma_f32_16x16x32_bf16 v[64:67], v[76:79], v[6:9], v[64:67]
    v_mfma_f32_16x16x32_bf16 v[72:75], v[80:83], v[2:5], 0
    v_mfma_f32_16x16x32_bf16 v[72:75], v[84:87], v[6:9], v[72:75]
    v_mfma_f32_16x16x32_bf16 v[80:83], v[88:91], v[2:5], 0
    v_mfma_f32_16x16x32_bf16 v[80:83], v[92:95], v[6:9], v[80:83]
    v_mfma_f32_16x16x32_bf16 v[88:91], v[96:99], v[2:5], 0
    v_mfma_f32_16x16x32_bf16 v[88:91], v[100:103], v[6:9], v[88:91]
    s_nop 1
    v_mov_b32_dpp v24, v16 quad_perm:[0,0,0,0] row_mask:0xf bank_mask:0xf
    v_mov_b32_dpp v25, v40 quad_perm:[0,0,0,0] row_mask:0xf bank_mask:0xf
    v_mov_b32_dpp v26, v48 quad_perm:[0,0,0,0] row_mask:0xf bank_mask:0xf
    v_mov_b32_dpp v27, v56 quad_perm:[0,0,0,0] row_mask:0xf bank_mask:0xf
    v_mov_b32_dpp v28, v64 quad_perm:[0,0,0,0] row_mask:0xf bank_mask:0xf
    v_mov_b32_dpp v29, v72 quad_perm:[0,0,0,0] row_mask:0xf bank_mask:0xf
    v_mov_b32_dpp v30, v80 quad_perm:[0,0,0,0] row_mask:0xf bank_mask:0xf
    v_mov_b32_dpp v31, v88 quad_perm:[0,0,0,0] row_mask:0xf bank_mask:0xf
    v_add_f32_dpp v24, v17, v24 quad_perm:[1,1,1,1] row_mask:0xf bank_mask:0xf
    v_add_f32_dpp v25, v41, v25 quad_perm:[1,1,1,1] row_mask:0xf bank_mask:0xf
    v_add_f32_dpp v26, v49, v26 quad_perm:[1,1,1,1] row_mask:0xf bank_mask:0xf
    v_add_f32_dpp v27, v57, v27 quad_perm:[1,1,1,1] row_mask:0xf bank_mask:0xf
    v_add_f32_dpp v28, v65, v28 quad_perm:[1,1,1,1] row_mask:0xf bank_mask:0xf
    v_add_f32_dpp v29, v73, v29 quad_perm:[1,1,1,1] row_mask:0xf bank_mask:0xf
    v_add_f32_dpp v30, v81, v30 quad_perm:[1,1,1,1] row_mask:0xf bank_mask:0xf
    v_add_f32_dpp v31, v89, v31 quad_perm:[1,1,1,1] row_mask:0xf bank_mask:0xf
    v_add_f32_dpp v24, v18, v24 quad_perm:[2,2,2,2] row_mask:0xf bank_mask:0xf
    v_add_f32_dpp v25, v42, v25 quad_perm:[2,2,2,2] row_mask:0xf bank_mask:0xf
    v_add_f32_dpp v26, v50, v26 quad_perm:[2,2,2,2] row_mask:0xf bank_mask:0xf
    v_add_f32_dpp v27, v58, v27 quad_perm:[2,2,2,2] row_mask:0xf bank_mask:0xf
    v_add_f32_dpp v28, v66, v28 quad_perm:[2,2,2,2] row_mask:0xf bank_mask:0xf
    v_add_f32_dpp v29, v74, v29 quad_perm:[2,2,2,2] row_mask:0xf bank_mask:0xf
    v_add_f32_dpp v30, v82, v30 quad_perm:[2,2,2,2] row_mask:0xf bank_mask:0xf
    v_add_f32_dpp v31, v90, v31 quad_perm:[2,2,2,2] row_mask:0xf bank_mask:0xf
    v_add_f32_dpp v24, v19, v24 quad_perm:[3,3,3,3] row_mask:0xf bank_mask:0xf
    v_add_f32_dpp v25, v43, v25 quad_perm:[3,3,3,3] row_mask:0xf bank_mask:0xf
    v_add_f32_dpp v26, v51, v26 quad_perm:[3,3,3,3] row_mask:0xf bank_mask:0xf
    v_add_f32_dpp v27, v59, v27 quad_perm:[3,3,3,3] row_mask:0xf bank_mask:0xf
    v_add_f32_dpp v28, v67, v28 quad_perm:[3,3,3,3] row_mask:0xf bank_mask:0xf
    v_add_f32_dpp v29, v75, v29 quad_perm:[3,3,3,3] row_mask:0xf bank_mask:0xf
    v_add_f32_dpp v30, v83, v30 quad_perm:[3,3,3,3] row_mask:0xf bank_mask:0xf
    v_add_f32_dpp v31, v91, v31 quad_perm:[3,3,3,3] row_mask:0xf bank_mask:0xf
    v_cvt_pk_bf16_f32 v24, v24, v24
    v_cvt_pk_bf16_f32 v25, v25, v25
    v_cvt_pk_bf16_f32 v26, v26, v26
    v_cvt_pk_bf16_f32 v27, v27, v27
    v_cvt_pk_bf16_f32 v28, v28, v28
    v_cvt_pk_bf16_f32 v29, v29, v29
    v_cvt_pk_bf16_f32 v30, v30, v30
    v_cvt_pk_bf16_f32 v31, v31, v31
    v_and_b32 v24, 0xffff0000, v24
    v_and_b32 v25, 0xffff0000, v25
    v_and_b32 v26, 0xffff0000, v26
    v_and_b32 v27, 0xffff0000, v27
    v_and_b32 v28, 0xffff0000, v28
    v_and_b32 v29, 0xffff0000, v29
    v_and_b32 v30, 0xffff0000, v30
    v_and_b32 v31, 0xffff0000, v31
    v_max3_f32 v32, v24, v25, v26
    v_max3_f32 v32, v32, v27, v28
    v_max3_f32 v32, v32, v29, v30
    v_max_f32 v32, v32, v31
    v_mov_b32 v34, v32
    s_nop 1
    v_permlane16_swap_b32 v32, v34
    v_max_f32 v32, v32, v34
    v_mov_b32 v34, v32
    s_nop 1
    v_permlane32_swap_b32 v32, v34
    v_max_f32 v32, v32, v34
    v_mul_f32 v32, s61, v32
    v_fma_f32 v24, v24, s61, -v32
    v_fma_f32 v25, v25, s61, -v32
    v_fma_f32 v26, v26, s61, -v32
    v_fma_f32 v27, v27, s61, -v32
    v_fma_f32 v28, v28, s61, -v32
    v_fma_f32 v29, v29, s61, -v32
    v_fma_f32 v30, v30, s61, -v32
    v_fma_f32 v31, v31, s61, -v32
    v_exp_f32 v24, v24
    v_exp_f32 v25, v25
    v_exp_f32 v26, v26
    v_exp_f32 v27, v27
    v_exp_f32 v28, v28
    v_exp_f32 v29, v29
    v_exp_f32 v30, v30
    v_exp_f32 v31, v31
    v_add_f32 v35, v24, v25
    v_add_f32 v36, v26, v27
    v_add_f32 v37, v28, v29
    v_add_f32 v38, v30, v31
    v_add_f32 v35, v35, v36
    v_add_f32 v37, v37, v38
    v_add_f32 v35, v35, v37
    v_mov_b32 v34, v35
    s_nop 1
    v_permlane16_swap_b32 v35, v34
    v_add_f32 v35, v35, v34
    v_mov_b32 v34, v35
    s_nop 1
    v_permlane32_swap_b32 v35, v34
    v_add_f32 v35, v35, v34
    v_and_b32 v36, 8, v1
    v_lshlrev_b32 v36, 2, v36
    s_lshl_b32 s53, s30, 2
    v_add_u32 v36, s53, v36
    v_mov_b32 v37, 1
    s_mov_b64 exec, 0x101
    ds_write_b32 v36, v32 offset:64
    ds_write_b32 v36, v35 offset:128
    s_mov_b64 exec, 1
    ds_add_u32 v33, v37 offset:4
    s_mov_b64 exec, -1
    v_cvt_pk_bf16_f32 v24, v24, v24
    v_cvt_pk_bf16_f32 v25, v25, v25
    v_cvt_pk_bf16_f32 v26, v26, v26
    v_cvt_pk_bf16_f32 v27, v27, v27
    v_cvt_pk_bf16_f32 v28, v28, v28
    v_cvt_pk_bf16_f32 v29, v29, v29
    v_cvt_pk_bf16_f32 v30, v30, v30
    v_cvt_pk_bf16_f32 v31, v31, v31
    v_and_b32 v40, v24, v10
    v_and_b32 v41, v24, v11
    v_and_b32 v42, v24, v12
    v_and_b32 v43, v24, v13
    v_and_b32 v44, v25, v10
    v_and_b32 v45, v25, v11
    v_and_b32 v46, v25, v12
    v_and_b32 v47, v25, v13
    v_and_b32 v48, v26, v10
    v_and_b32 v49, v26, v11
    v_and_b32 v50, v26, v12
    v_and_b32 v51, v26, v13
    v_and_b32 v52, v27, v10
    v_and_b32 v53, v27, v11
    v_and_b32 v54, v27, v12
    v_and_b32 v55, v27, v13
    v_and_b32 v56, v28, v10
    v_and_b32 v57, v28, v11
    v_and_b32 v58, v28, v12
    v_and_b32 v59, v28, v13
    v_and_b32 v60, v29, v10
    v_and_b32 v61, v29, v11
    v_and_b32 v62, v29, v12
    v_and_b32 v63, v29, v13
    v_and_b32 v64, v30, v10
    v_and_b32 v65, v30, v11
    v_and_b32 v66, v30, v12
    v_and_b32 v67, v30, v13
    v_and_b32 v68, v31, v10
    v_and_b32 v69, v31, v11
    v_and_b32 v70, v31, v12
    v_and_b32 v71, v31, v13
L_scored:
    s_lshl_b32 s53, s30, 11
    v_lshl_add_u32 v33, v1, 4, s53
    v_lshrrev_b32 v4, 4, v1
    v_and_b32 v5, 15, v1
    v_lshlrev_b32 v7, 4, v5
    v_and_b32 v8, 1, v4
    v_lshlrev_b32 v8, 1, v8
    v_lshrrev_b32 v9, 1, v4
    v_or_b32 v8, v8, v9
    s_and_b32 s53, s30, 1
    s_lshl_b32 s55, s53, 6
    v_mov_b32 v2, s55
    s_lshl_b32 s55, s30, 9
    v_lshl_add_u32 v3, v1, 4, s55
    s_lshl_b32 s54, s35, 11
    s_add_u32 s54, s54, 524288
    v_lshl_add_u32 v14, v4, 12, v7
    s_lshr_b32 s57, s30, 2
    s_and_b32 s56, s32, 2
    s_add_u32 s56, s56, s57
    s_lshl3_add_u32 s56, s56, s31
    s_lshl_b32 s56, s56, 14
    s_and_b32 s52, s32, 1
    s_and_b32 s55, s30, 2
    s_add_u32 s55, s55, s52
    s_lshl1_add_u32 s55, s55, s53
    s_lshl_b32 s55, s55, 8
    s_add_u32 s56, s56, s55
    s_add_u32 s56, s56, 524288
    s_lshl_b32 s55, s57, 6
    v_lshl_add_u32 v36, v4, 4, s55
    s_lshr_b32 s55, s30, 1
    s_lshl_b32 s55, s55, 8
    s_lshl3_add_u32 s55, s53, s55
    s_lshl_b32 s57, s57, 5
    s_add_u32 s55, s55, s57
    v_lshl_add_u32 v15, v8, 1, v7
    v_add_u32 v15, s55, v15
    v_bfe_u32 v6, v1, 3, 1
    v_and_b32 v9, 1, v4
    v_lshl_add_u32 v6, v9, 1, v6
    v_add_u32 v6, s30, v6
    v_and_b32 v6, 3, v6
    v_lshlrev_b32 v6, 5, v6
    v_lshl_add_u32 v6, v4, 10, v6
    v_bfe_u32 v9, v1, 2, 2
    v_lshl_add_u32 v6, v9, 7, v6
    v_and_b32 v9, 3, v1
    v_lshl_add_u32 v6, v9, 3, v6
    v_add_u32 v6, 55296, v6
    v_and_b32 v9, 1, v1
    v_lshlrev_b32 v35, 4, v4
    v_mul_u32_u24 v32, 544, v9
    v_add_u32 v32, v32, v35
    v_lshl_add_u32 v35, v9, 15, v35
    v_mov_b32 v37, 0
    s_and_b32 s57, s32, 2
    s_lshl3_add_u32 s57, s57, s31
    s_lshl1_add_u32 s57, s57, s52
    s_lshl3_add_u32 s57, s57, s33
    s_and_b32 s55, s30, 3
    s_lshl2_add_u32 s57, s57, s55
    s_lshl_b32 s57, s57, 6
    s_add_u32 s57, s57, 1572864
L_pv:
    s_cmp_ge_u32 s30, 4
    s_cselect_b64 vcc, -1, 0
    s_waitcnt vmcnt(14)
    v_mfma_f32_16x16x32_bf16 v[16:19], v[40:43], v[104:107], 0
    v_mfma_f32_16x16x32_bf16 v[20:23], v[40:43], v[108:111], 0
    s_waitcnt vmcnt(12)
    v_mfma_f32_16x16x32_bf16 v[16:19], v[44:47], v[112:115], v[16:19]
    v_mfma_f32_16x16x32_bf16 v[20:23], v[44:47], v[116:119], v[20:23]
    s_waitcnt vmcnt(10)
    v_mfma_f32_16x16x32_bf16 v[16:19], v[48:51], v[120:123], v[16:19]
    v_mfma_f32_16x16x32_bf16 v[20:23], v[48:51], v[124:127], v[20:23]
    s_waitcnt vmcnt(8)
    v_mfma_f32_16x16x32_bf16 v[16:19], v[52:55], v[128:131], v[16:19]
    v_mfma_f32_16x16x32_bf16 v[20:23], v[52:55], v[132:135], v[20:23]
    s_waitcnt vmcnt(6)
    v_mfma_f32_16x16x32_bf16 v[16:19], v[56:59], v[136:139], v[16:19]
    v_mfma_f32_16x16x32_bf16 v[20:23], v[56:59], v[140:143], v[20:23]
    s_waitcnt vmcnt(4)
    v_mfma_f32_16x16x32_bf16 v[16:19], v[60:63], v[144:147], v[16:19]
    v_mfma_f32_16x16x32_bf16 v[20:23], v[60:63], v[148:151], v[20:23]
    s_waitcnt vmcnt(2)
    v_mfma_f32_16x16x32_bf16 v[16:19], v[64:67], v[152:155], v[16:19]
    v_mfma_f32_16x16x32_bf16 v[20:23], v[64:67], v[156:159], v[20:23]
    s_waitcnt vmcnt(0)
    v_mfma_f32_16x16x32_bf16 v[16:19], v[68:71], v[160:163], v[16:19]
    v_mfma_f32_16x16x32_bf16 v[20:23], v[68:71], v[164:167], v[20:23]
    s_nop 6
    ds_write_b128 v33, v[16:19] offset:38912
    ds_write_b128 v33, v[20:23] offset:39936
    s_cmp_eq_u32 s59, 1
    s_waitcnt lgkmcnt(0)
    s_barrier
    s_cbranch_vccnz L_nored
    s_mov_b32 exec_hi, 0
    ds_read_b128 v[152:155], v2 offset:7680
    ds_read_b128 v[120:123], v3 offset:38912
    ds_read_b128 v[124:127], v3 offset:40960
    ds_read_b128 v[156:159], v2 offset:7696
    ds_read_b128 v[128:131], v3 offset:43008
    ds_read_b128 v[132:135], v3 offset:45056
    ds_read_b128 v[160:163], v2 offset:7712
    ds_read_b128 v[136:139], v3 offset:47104
    ds_read_b128 v[140:143], v3 offset:49152
    ds_read_b128 v[164:167], v2 offset:7728
    ds_read_b128 v[144:147], v3 offset:51200
    ds_read_b128 v[148:151], v3 offset:53248
    s_waitcnt lgkmcnt(10)
    v_pk_mul_f32 v[16:17], v[120:121], v[152:153]
    v_pk_mul_f32 v[18:19], v[122:123], v[152:153]
    s_waitcnt lgkmcnt(9)
    v_pk_fma_f32 v[16:17], v[124:125], v[154:155], v[16:17]
    v_pk_fma_f32 v[18:19], v[126:127], v[154:155], v[18:19]
    s_waitcnt lgkmcnt(7)
    v_pk_fma_f32 v[16:17], v[128:129], v[156:157], v[16:17]
    v_pk_fma_f32 v[18:19], v[130:131], v[156:157], v[18:19]
    s_waitcnt lgkmcnt(6)
    v_pk_fma_f32 v[16:17], v[132:133], v[158:159], v[16:17]
    v_pk_fma_f32 v[18:19], v[134:135], v[158:159], v[18:19]
    s_waitcnt lgkmcnt(4)
    v_pk_fma_f32 v[16:17], v[136:137], v[160:161], v[16:17]
    v_pk_fma_f32 v[18:19], v[138:139], v[160:161], v[18:19]
    s_waitcnt lgkmcnt(3)
    v_pk_fma_f32 v[16:17], v[140:141], v[162:163], v[16:17]
    v_pk_fma_f32 v[18:19], v[142:143], v[162:163], v[18:19]
    s_waitcnt lgkmcnt(1)
    v_pk_fma_f32 v[16:17], v[144:145], v[164:165], v[16:17]
    v_pk_fma_f32 v[18:19], v[146:147], v[164:165], v[18:19]
    s_waitcnt lgkmcnt(0)
    v_pk_fma_f32 v[16:17], v[148:149], v[166:167], v[16:17]
    v_pk_fma_f32 v[18:19], v[150:151], v[166:167], v[18:19]
    v_min_u32 v16, -2, v16
    v_min_u32 v17, -2, v17
    v_min_u32 v18, -2, v18
    v_min_u32 v19, -2, v19
    s_cbranch_scc1 L_pubg
    buffer_store_dwordx4 v[16:19], v3, s[48:51], s54 offen
    s_branch L_pubd
L_pubg:
    buffer_store_dwordx4 v[16:19], v3, s[48:51], s54 offen sc1
L_pubd:
    s_mov_b64 exec, -1
L_nored:
    s_cmp_eq_u32 s33, 7
    s_cbranch_scc1 L_t7
    s_cmp_lt_u32 s30, 4
    s_cbranch_scc1 L_nofrag
    s_mov_b32 s60, 0
    s_branch L_wof_4
L_wo_5:
    s_sleep 1
L_wof_4:
    ds_read_b32 v38, v37 offset:16
    s_waitcnt lgkmcnt(0)
    v_cmp_ne_u32 vcc, 3, v38
    s_cbranch_vccz L_out_6
    s_add_u32 s60, s60, 1
    s_cmp_le_u32 s60, 200000
    s_cbranch_scc1 L_wo_5
L_out_6:
    ds_read_b64_tr_b16 v[72:73], v6 offset:0
    ds_read_b64_tr_b16 v[74:75], v6 offset:512
    ds_read_b64_tr_b16 v[76:77], v6 offset:4096
    ds_read_b64_tr_b16 v[78:79], v6 offset:4608
    ds_read_b64_tr_b16 v[80:81], v6 offset:8192
    ds_read_b64_tr_b16 v[82:83], v6 offset:8704
    ds_read_b64_tr_b16 v[84:85], v6 offset:12288
    ds_read_b64_tr_b16 v[86:87], v6 offset:12800
    ds_read_b64_tr_b16 v[88:89], v6 offset:16384
    ds_read_b64_tr_b16 v[90:91], v6 offset:16896
    ds_read_b64_tr_b16 v[92:93], v6 offset:20480
    ds_read_b64_tr_b16 v[94:95], v6 offset:20992
    ds_read_b64_tr_b16 v[96:97], v6 offset:24576
    ds_read_b64_tr_b16 v[98:99], v6 offset:25088
    ds_read_b64_tr_b16 v[100:101], v6 offset:28672
    ds_read_b64_tr_b16 v[102:103], v6 offset:29184
L_nofrag:
    buffer_load_dwordx4 v[104:107], v14, s[48:51], s56 offen sc1
    buffer_load_dwordx4 v[108:111], v14, s[48:51], s56 offen offset:2048 sc1
    s_mov_b32 s60, 0
    ds_read_b128 v[24:27], v36 offset:7808
    s_waitcnt vmcnt(0)
    v_max3_u32 v10, v104, v105, v106
    v_max3_u32 v11, v108, v109, v110
    v_max_u32 v10, v10, v107
    v_max_u32 v11, v11, v111
    v_cmp_eq_u32 s[40:41], -1, v10
    v_cmp_eq_u32 s[42:43], -1, v11
    s_waitcnt lgkmcnt(0)
    v_max_u32 v12, v24, v26
    v_cmp_eq_u32 vcc, -1, v12
    s_or_b64 s[62:63], s[40:41], s[42:43]
    s_or_b64 s[62:63], s[62:63], vcc
    s_cbranch_scc0 L_h1_ok
L_h1:
    s_mov_b64 exec, s[40:41]
    buffer_load_dwordx4 v[104:107], v14, s[48:51], s56 offen sc1
    s_mov_b64 exec, s[42:43]
    buffer_load_dwordx4 v[108:111], v14, s[48:51], s56 offen offset:2048 sc1
    s_mov_b64 exec, -1
    s_add_u32 s60, s60, 1
    s_cmp_gt_u32 s60, 200000
    s_cbranch_scc1 L_h1_ok
    s_sleep 1
    ds_read_b128 v[24:27], v36 offset:7808
    s_waitcnt vmcnt(2)
    v_max3_u32 v10, v104, v105, v106
    v_max3_u32 v11, v108, v109, v110
    v_max_u32 v10, v10, v107
    v_max_u32 v11, v11, v111
    v_cmp_eq_u32 s[40:41], -1, v10
    v_cmp_eq_u32 s[42:43], -1, v11
    s_waitcnt lgkmcnt(0)
    v_max_u32 v12, v24, v26
    v_cmp_eq_u32 vcc, -1, v12
    s_or_b64 s[62:63], s[40:41], s[42:43]
    s_or_b64 s[62:63], s[62:63], vcc
    s_cbranch_scc1 L_h1
L_h1_ok:
    v_pk_mul_f32 v[16:17], v[104:105], v[24:25]
    v_pk_mul_f32 v[18:19], v[106:107], v[24:25]
    v_pk_fma_f32 v[16:17], v[108:109], v[26:27], v[16:17]
    v_pk_fma_f32 v[18:19], v[110:111], v[26:27], v[18:19]
    s_nop 1
    v_permlane32_swap_b32 v16, v17
    v_permlane32_swap_b32 v18, v19
    v_add_f32 v16, v16, v17
    v_add_f32 v18, v18, v19
    s_nop 1
    v_permlane16_swap_b32 v16, v18
    v_add_f32 v16, v16, v18
    v_cvt_pk_bf16_f32 v16, v16, v16
    ds_write_b16 v15, v16 offset:1280
    s_waitcnt lgkmcnt(0)
    s_barrier
    s_cmp_lt_u32 s30, 4
    s_cbranch_scc1 L_end
    ds_read_b128 v[40:43], v32 offset:1280
    ds_read_b128 v[44:47], v32 offset:1344
    ds_read_b128 v[48:51], v32 offset:1408
    ds_read_b128 v[52:55], v32 offset:1472
    ds_read_b128 v[56:59], v32 offset:1536
    ds_read_b128 v[60:63], v32 offset:1600
    ds_read_b128 v[64:67], v32 offset:1664
    ds_read_b128 v[68:71], v32 offset:1728
    s_waitcnt lgkmcnt(7)
    v_mfma_f32_16x16x32_bf16 v[16:19], v[72:75], v[40:43], 0
    s_waitcnt lgkmcnt(6)
    v_mfma_f32_16x16x32_bf16 v[16:19], v[76:79], v[44:47], v[16:19]
    s_waitcnt lgkmcnt(5)
    v_mfma_f32_16x16x32_bf16 v[16:19], v[80:83], v[48:51], v[16:19]
    s_waitcnt lgkmcnt(4)
    v_mfma_f32_16x16x32_bf16 v[16:19], v[84:87], v[52:55], v[16:19]
    s_waitcnt lgkmcnt(3)
    v_mfma_f32_16x16x32_bf16 v[16:19], v[88:91], v[56:59], v[16:19]
    s_waitcnt lgkmcnt(2)
    v_mfma_f32_16x16x32_bf16 v[16:19], v[92:95], v[60:63], v[16:19]
    s_waitcnt lgkmcnt(1)
    v_mfma_f32_16x16x32_bf16 v[16:19], v[96:99], v[64:67], v[16:19]
    s_waitcnt lgkmcnt(0)
    v_mfma_f32_16x16x32_bf16 v[16:19], v[100:103], v[68:71], v[16:19]
    s_mov_b32 exec_lo, 0x00030003
    s_mov_b32 exec_hi, 0x00030003
    s_nop 5
    v_min_u32 v16, -2, v16
    v_min_u32 v17, -2, v17
    v_min_u32 v18, -2, v18
    v_min_u32 v19, -2, v19
    buffer_store_dwordx4 v[16:19], v35, s[48:51], s57 offen sc1
    s_endpgm
L_t7:
    s_lshl_b32 s53, s32, 1
    s_add_u32 s53, s53, 0
    s_and_b32 s53, s53, 7
    s_cmp_lg_u32 s53, s31
    s_cbranch_scc1 L_end
    s_cmp_eq_u32 s30, 7
    s_cbranch_scc1 L_end
    s_lshl_b32 s53, s30, 6
    v_lshl_add_u32 v33, v5, 2, v8
    v_add_u32 v33, s53, v33
    v_lshlrev_b32 v35, 1, v33
    v_lshlrev_b32 v33, 2, v33
    s_mul_i32 s58, s32, 896
    v_add_u32 v34, s58, v35
    ds_read_u16 v34, v34 offset:34816
    v_mov_b32 v3, 0
    ds_read_b64 v[38:39], v3 offset:24
    v_mov_b32 v32, s58
    ds_read_u16 v32, v32 offset:34816
    v_mov_b32 v28, 0
    v_mov_b32 v29, 0
    ds_write_b64 v3, v[28:29] offset:2360
    s_lshl_b32 s53, s30, 3
    v_mov_b32 v33, s53
    v_lshlrev_b32 v2, 3, v1
    v_lshlrev_b32 v9, 4, v1
    v_bfe_u32 v11, v1, 1, 3
    v_lshlrev_b32 v11, 15, v11
    v_and_b32 v12, 1, v1
    v_lshl_add_u32 v11, v12, 11, v11
    s_lshr_b32 s53, s32, 1
    s_lshl2_add_u32 s53, s30, s53
    s_lshl_b32 s53, s53, 10
    s_add_u32 s53, s53, 65540
    s_min_u32 s54, s30, 5
    s_mul_i32 s54, s54, 4096
    s_add_u32 s55, s54, 16384
    s_lshr_b32 s54, s54, 1
    s_add_u32 s54, s54, 55296
    v_add_u32 v6, s54, v2
    s_waitcnt lgkmcnt(0)
    s_mov_b32 s60, 0
    s_branch L_lgf_7
L_lg_8:
    s_sleep 4
L_lgf_7:
    buffer_load_dword v10, v11, s[48:51], s53 offen sc1
    buffer_load_dwordx4 v[40:43], v9, s[48:51], s55 offen offset:0 sc1
    buffer_load_dwordx4 v[44:47], v9, s[48:51], s55 offen offset:1024 sc1
    buffer_load_dwordx4 v[48:51], v9, s[48:51], s55 offen offset:2048 sc1
    buffer_load_dwordx4 v[52:55], v9, s[48:51], s55 offen offset:3072 sc1
    s_waitcnt vmcnt(0)
    v_xor_b32 v10, v38, v10
    v_xor_b32 v41, v38, v41
    v_xor_b32 v43, v38, v43
    v_or3_b32 v10, v10, v41, v43
    v_xor_b32 v45, v38, v45
    v_xor_b32 v47, v38, v47
    v_or3_b32 v10, v10, v45, v47
    v_xor_b32 v49, v38, v49
    v_xor_b32 v51, v38, v51
    v_or3_b32 v10, v10, v49, v51
    v_xor_b32 v53, v38, v53
    v_xor_b32 v55, v38, v55
    v_or3_b32 v10, v10, v53, v55
    v_cmp_ne_u32 vcc, 0, v10
    s_cbranch_vccz L_out_9
    s_add_u32 s60, s60, 1
    s_cmp_le_u32 s60, 200000
    s_cbranch_scc1 L_lg_8
L_out_9:
    v_mov_b32 v41, v42
    ds_write_b64 v6, v[40:41] offset:0
    v_mov_b32 v45, v46
    ds_write_b64 v6, v[44:45] offset:512
    v_mov_b32 v49, v50
    ds_write_b64 v6, v[48:49] offset:1024
    v_mov_b32 v53, v54
    ds_write_b64 v6, v[52:53] offset:1536
    v_lshl_add_u32 v14, v4, 11, v7
    s_lshl_b32 s52, s32, 7
    s_add_u32 s52, s52, s30
    s_lshl_b32 s52, s52, 8
    s_add_u32 s66, s52, 1572864
    s_add_u32 s67, s52, 1581056
    s_add_u32 s68, s52, 1589248
    s_add_u32 s69, s52, 1597440
    s_mov_b32 s36, s24
    s_mov_b32 s37, s25
    s_mov_b32 s38, 3584
    s_mov_b32 s39, 0x20000
    v_lshlrev_b32 v2, 2, v1
    s_mov_b32 s61, 0x3b124925
    s_mov_b32 s62, 0x3727c5ac
    v_lshlrev_b32 v34, 16, v34
    v_lshlrev_b32 v32, 16, v32
    v_and_b32 v2, 7, v1
    v_lshlrev_b32 v2, 3, v2
    buffer_load_dwordx4 v[128:131], v14, s[48:51], s66 offen sc1
    buffer_load_dwordx4 v[132:135], v14, s[48:51], s67 offen sc1
    buffer_load_dwordx4 v[136:139], v14, s[48:51], s68 offen sc1
    buffer_load_dwordx4 v[140:143], v14, s[48:51], s69 offen sc1
    s_mov_b32 s60, 0
    s_waitcnt vmcnt(0)
    v_max3_u32 v18, v128, v129, v130
    v_max3_u32 v19, v132, v133, v134
    v_max3_u32 v20, v136, v137, v138
    v_max3_u32 v21, v140, v141, v142
    v_max_u32 v18, v18, v131
    v_max_u32 v19, v19, v135
    v_max_u32 v20, v20, v139
    v_max_u32 v21, v21, v143
    v_cmp_eq_u32 s[40:41], -1, v18
    v_cmp_eq_u32 s[42:43], -1, v19
    v_cmp_eq_u32 s[44:45], -1, v20
    v_cmp_eq_u32 s[46:47], -1, v21
    s_or_b64 s[62:63], s[40:41], s[42:43]
    s_or_b64 s[62:63], s[62:63], s[44:45]
    s_or_b64 s[62:63], s[62:63], s[46:47]
    s_cbranch_scc0 L_h2_ok
L_h2:
    s_mov_b64 exec, s[40:41]
    buffer_load_dwordx4 v[128:131], v14, s[48:51], s66 offen sc1
    s_mov_b64 exec, s[42:43]
    buffer_load_dwordx4 v[132:135], v14, s[48:51], s67 offen sc1
    s_mov_b64 exec, s[44:45]
    buffer_load_dwordx4 v[136:139], v14, s[48:51], s68 offen sc1
    s_mov_b64 exec, s[46:47]
    buffer_load_dwordx4 v[140:143], v14, s[48:51], s69 offen sc1
    s_mov_b64 exec, -1
    s_add_u32 s60, s60, 1
    s_cmp_gt_u32 s60, 200000
    s_cbranch_scc1 L_h2_ok
    s_sleep 3
    s_waitcnt vmcnt(4)
    v_max3_u32 v18, v128, v129, v130
    v_max3_u32 v19, v132, v133, v134
    v_max3_u32 v20, v136, v137, v138
    v_max3_u32 v21, v140, v141, v142
    v_max_u32 v18, v18, v131
    v_max_u32 v19, v19, v135
    v_max_u32 v20, v20, v139
    v_max_u32 v21, v21, v143
    v_cmp_eq_u32 s[40:41], -1, v18
    v_cmp_eq_u32 s[42:43], -1, v19
    v_cmp_eq_u32 s[44:45], -1, v20
    v_cmp_eq_u32 s[46:47], -1, v21
    s_or_b64 s[62:63], s[40:41], s[42:43]
    s_or_b64 s[62:63], s[62:63], s[44:45]
    s_or_b64 s[62:63], s[62:63], s[46:47]
    s_cbranch_scc1 L_h2
L_h2_ok:
    s_mov_b32 s62, 0x3727c5ac
    v_pk_add_f32 v[16:17], v[128:129], v[132:133]
    v_pk_add_f32 v[18:19], v[130:131], v[134:135]
    v_pk_add_f32 v[24:25], v[136:137], v[140:141]
    v_pk_add_f32 v[26:27], v[138:139], v[142:143]
    v_pk_add_f32 v[16:17], v[16:17], v[24:25]
    v_pk_add_f32 v[18:19], v[18:19], v[26:27]
    s_nop 1
    v_permlane32_swap_b32 v16, v17
    v_permlane32_swap_b32 v18, v19
    v_add_f32 v16, v16, v17
    v_add_f32 v18, v18, v19
    s_nop 1
    v_permlane16_swap_b32 v16, v18
    v_add_f32 v16, v16, v18
    v_cvt_pk_bf16_f32 v16, v16, v16
    v_and_b32 v16, 0xffff0000, v16
    v_add_f32 v16, v16, v34
    v_cvt_pk_bf16_f32 v16, v16, v16
    v_and_b32 v16, 0xffff0000, v16
    v_sub_f32 v6, v16, v32
    v_mul_f32 v7, v6, v6
    s_nop 0
    v_add_f32_dpp v6, v6, v6 quad_perm:[1,0,3,2] row_mask:0xf bank_mask:0xf
    v_add_f32_dpp v7, v7, v7 quad_perm:[1,0,3,2] row_mask:0xf bank_mask:0xf
    s_nop 0
    v_add_f32_dpp v6, v6, v6 quad_perm:[2,3,0,1] row_mask:0xf bank_mask:0xf
    v_add_f32_dpp v7, v7, v7 quad_perm:[2,3,0,1] row_mask:0xf bank_mask:0xf
    s_nop 0
    v_add_f32_dpp v6, v6, v6 row_half_mirror row_mask:0xf bank_mask:0xf
    v_add_f32_dpp v7, v7, v7 row_half_mirror row_mask:0xf bank_mask:0xf
    s_nop 0
    v_add_f32_dpp v6, v6, v6 row_mirror row_mask:0xf bank_mask:0xf
    v_add_f32_dpp v7, v7, v7 row_mirror row_mask:0xf bank_mask:0xf
    s_nop 0
    v_add_f32_dpp v6, v6, v6 row_bcast:15 row_mask:0xa bank_mask:0xf
    v_add_f32_dpp v7, v7, v7 row_bcast:15 row_mask:0xa bank_mask:0xf
    s_nop 0
    v_add_f32_dpp v6, v6, v6 row_bcast:31 row_mask:0xc bank_mask:0xf
    v_add_f32_dpp v7, v7, v7 row_bcast:31 row_mask:0xc bank_mask:0xf
    s_mov_b32 exec_lo, 0
    s_brev_b32 exec_hi, 1
    ds_write_b64 v33, v[6:7] offset:2304
    s_mov_b64 exec, -1
    s_waitcnt lgkmcnt(0)
    s_barrier
    ds_read_b64 v[6:7], v2 offset:2304
    s_waitcnt lgkmcnt(0)
    v_add_f32_dpp v6, v6, v6 quad_perm:[1,0,3,2] row_mask:0xf bank_mask:0xf
    v_add_f32_dpp v7, v7, v7 quad_perm:[1,0,3,2] row_mask:0xf bank_mask:0xf
    s_nop 0
    v_add_f32_dpp v6, v6, v6 quad_perm:[2,3,0,1] row_mask:0xf bank_mask:0xf
    v_add_f32_dpp v7, v7, v7 quad_perm:[2,3,0,1] row_mask:0xf bank_mask:0xf
    s_nop 0
    v_add_f32_dpp v6, v6, v6 row_half_mirror row_mask:0xf bank_mask:0xf
    v_add_f32_dpp v7, v7, v7 row_half_mirror row_mask:0xf bank_mask:0xf
    s_nop 0
    v_mul_f32 v6, s61, v6
    v_mul_f32 v7, s61, v7
    v_fma_f32 v7, -v6, v6, v7
    v_add_f32 v6, v32, v6
    v_max_f32 v7, 0, v7
    v_cvt_pk_bf16_f32 v8, v6, v7
    v_and_b32 v9, 0xffff0000, v8
    v_lshlrev_b32 v8, 16, v8
    v_add_f32 v9, s62, v9
    v_sub_f32 v17, v16, v8
    v_cvt_pk_bf16_f32 v9, v9, v9
    v_and_b32 v9, 0xffff0000, v9
    v_sqrt_f32 v9, v9
    v_sub_f32 v6, v6, v8
    v_cvt_pk_bf16_f32 v17, v17, v17
    v_cvt_pk_bf16_f32 v9, v9, v9
    v_and_b32 v9, 0xffff0000, v9
    v_rcp_f32 v10, v9
    v_and_b32 v17, 0xffff0000, v17
    v_mul_f32 v6, v6, v10
    v_mul_f32 v7, v7, v10
    v_mul_f32 v17, v17, v10
    v_mul_f32 v7, v7, v10
    v_cvt_pk_bf16_f32 v17, v17, v17
    v_cvt_pk_bf16_f32 v12, v6, v7
    v_and_b32 v17, 0xffff0000, v17
    v_and_b32 v13, 0xffff0000, v12
    v_lshlrev_b32 v12, 16, v12
    v_add_f32 v13, s62, v13
    v_sub_f32 v17, v17, v12
    v_cvt_pk_bf16_f32 v13, v13, v13
    v_and_b32 v13, 0xffff0000, v13
    v_sqrt_f32 v13, v13
    v_cvt_pk_bf16_f32 v17, v17, v17
    v_cvt_pk_bf16_f32 v13, v13, v13
    v_and_b32 v13, 0xffff0000, v13
    v_rcp_f32 v10, v13
    v_and_b32 v17, 0xffff0000, v17
    v_mul_f32 v17, v17, v10
    v_cvt_pk_bf16_f32 v17, v17, v17
    v_and_b32 v18, 0x7fff, v17
    v_subrev_u32 v18, 13824, v18
    v_bfe_u32 v19, v17, 15, 1
    v_cmp_le_u32 vcc, 3072, v18
    v_min_u32 v18, 3071, v18
    v_mul_u32_u24 v19, 3072, v19
    v_add_lshl_u32 v18, v18, v19, 1
    ds_read_u16 v20, v18 offset:55296
    s_mov_b64 s[40:41], vcc
    s_waitcnt lgkmcnt(0)
    v_lshlrev_b32 v20, 16, v20
    s_cbranch_vccnz L_fb
L_fb_done:
    v_add_f32 v20, v20, v16
    v_cvt_pk_bf16_f32 v20, v20, v20
    buffer_store_short v20, v35, s[36:39], s58 offen
    s_add_u32 s53, s32, s30
    s_cmp_lg_u32 s53, 0
    s_cbranch_scc1 L_noep
    s_mov_b32 s53, 327680
    s_mov_b64 exec, 1
    buffer_store_dword v38, v3, s[48:51], s53 offen sc1
L_noep:
    s_endpgm
L_fb:
    s_waitcnt vmcnt(0)
    v_and_b32 v17, 0xffff0000, v17
    v_lshlrev_b32 v9, 3, v1
    ds_read_b64 v[128:129], v9 offset:8192
    ds_read_b64 v[130:131], v9 offset:8704
    ds_read_b64 v[132:133], v9 offset:9216
    ds_read_b64 v[134:135], v9 offset:9728
    ds_read_b64 v[136:137], v9 offset:10240
    ds_read_b64 v[138:139], v9 offset:10752
    ds_read_b64 v[140:141], v9 offset:11264
    s_waitcnt lgkmcnt(0)
    v_lshlrev_b32 v40, 16, v128
    v_and_b32 v41, 0xffff0000, v128
    v_lshlrev_b32 v42, 16, v129
    v_and_b32 v43, 0xffff0000, v129
    v_lshlrev_b32 v44, 16, v130
    v_and_b32 v45, 0xffff0000, v130
    v_lshlrev_b32 v46, 16, v131
    v_and_b32 v47, 0xffff0000, v131
    v_lshlrev_b32 v48, 16, v132
    v_and_b32 v49, 0xffff0000, v132
    v_lshlrev_b32 v50, 16, v133
    v_and_b32 v51, 0xffff0000, v133
    v_lshlrev_b32 v52, 16, v134
    v_and_b32 v53, 0xffff0000, v134
    v_lshlrev_b32 v54, 16, v135
    v_and_b32 v55, 0xffff0000, v135
    v_lshlrev_b32 v56, 16, v136
    v_and_b32 v57, 0xffff0000, v136
    v_lshlrev_b32 v58, 16, v137
    v_and_b32 v59, 0xffff0000, v137
    v_lshlrev_b32 v60, 16, v138
    v_and_b32 v61, 0xffff0000, v138
    v_lshlrev_b32 v62, 16, v139
    v_and_b32 v63, 0xffff0000, v139
    v_lshlrev_b32 v64, 16, v140
    v_and_b32 v65, 0xffff0000, v140
    v_lshlrev_b32 v66, 16, v141
    v_and_b32 v67, 0xffff0000, v141
    ds_read_b64 v[128:129], v9 offset:12288
    ds_read_b64 v[130:131], v9 offset:12800
    ds_read_b64 v[132:133], v9 offset:13312
    ds_read_b64 v[134:135], v9 offset:13824
    ds_read_b64 v[136:137], v9 offset:14336
    ds_read_b64 v[138:139], v9 offset:14848
    ds_read_b64 v[140:141], v9 offset:15360
    s_waitcnt lgkmcnt(0)
    v_lshlrev_b32 v68, 16, v128
    v_and_b32 v69, 0xffff0000, v128
    v_lshlrev_b32 v70, 16, v129
    v_and_b32 v71, 0xffff0000, v129
    v_lshlrev_b32 v72, 16, v130
    v_and_b32 v73, 0xffff0000, v130
    v_lshlrev_b32 v74, 16, v131
    v_and_b32 v75, 0xffff0000, v131
    v_lshlrev_b32 v76, 16, v132
    v_and_b32 v77, 0xffff0000, v132
    v_lshlrev_b32 v78, 16, v133
    v_and_b32 v79, 0xffff0000, v133
    v_lshlrev_b32 v80, 16, v134
    v_and_b32 v81, 0xffff0000, v134
    v_lshlrev_b32 v82, 16, v135
    v_and_b32 v83, 0xffff0000, v135
    v_lshlrev_b32 v84, 16, v136
    v_and_b32 v85, 0xffff0000, v136
    v_lshlrev_b32 v86, 16, v137
    v_and_b32 v87, 0xffff0000, v137
    v_lshlrev_b32 v88, 16, v138
    v_and_b32 v89, 0xffff0000, v138
    v_lshlrev_b32 v90, 16, v139
    v_and_b32 v91, 0xffff0000, v139
    v_lshlrev_b32 v92, 16, v140
    v_and_b32 v93, 0xffff0000, v140
    v_lshlrev_b32 v94, 16, v141
    v_and_b32 v95, 0xffff0000, v141
    ds_read_b64 v[128:129], v9 offset:16384
    ds_read_b64 v[130:131], v9 offset:16896
    ds_read_b64 v[132:133], v9 offset:17408
    ds_read_b64 v[134:135], v9 offset:17920
    ds_read_b64 v[136:137], v9 offset:18432
    ds_read_b64 v[138:139], v9 offset:18944
    ds_read_b64 v[140:141], v9 offset:19456
    s_waitcnt lgkmcnt(0)
    v_lshlrev_b32 v96, 16, v128
    v_and_b32 v97, 0xffff0000, v128
    v_lshlrev_b32 v98, 16, v129
    v_and_b32 v99, 0xffff0000, v129
    v_lshlrev_b32 v100, 16, v130
    v_and_b32 v101, 0xffff0000, v130
    v_lshlrev_b32 v102, 16, v131
    v_and_b32 v103, 0xffff0000, v131
    v_lshlrev_b32 v104, 16, v132
    v_and_b32 v105, 0xffff0000, v132
    v_lshlrev_b32 v106, 16, v133
    v_and_b32 v107, 0xffff0000, v133
    v_lshlrev_b32 v108, 16, v134
    v_and_b32 v109, 0xffff0000, v134
    v_lshlrev_b32 v110, 16, v135
    v_and_b32 v111, 0xffff0000, v135
    v_lshlrev_b32 v112, 16, v136
    v_and_b32 v113, 0xffff0000, v136
    v_lshlrev_b32 v114, 16, v137
    v_and_b32 v115, 0xffff0000, v137
    v_lshlrev_b32 v116, 16, v138
    v_and_b32 v117, 0xffff0000, v138
    v_lshlrev_b32 v118, 16, v139
    v_and_b32 v119, 0xffff0000, v139
    v_lshlrev_b32 v120, 16, v140
    v_and_b32 v121, 0xffff0000, v140
    v_lshlrev_b32 v122, 16, v141
    v_and_b32 v123, 0xffff0000, v141
    v_mov_b32 v124, 0xbdd2d3e8
    v_mov_b32 v125, 0xbdd2d3e8
    v_mov_b32 v126, 0xc0135761
    v_mov_b32 v127, 0xc0135761
L_fb_loop:
    s_ff1_i32_b64 s53, s[40:41]
    s_bitset0_b64 s[40:41], s53
    v_readlane_b32 s54, v17, s53
    v_mov_b32 v22, 0
    v_mov_b32 v23, 0
    v_mov_b32 v24, s54
    v_pk_fma_f32 v[128:129], v[24:25], v[40:41], v[68:69] op_sel_hi:[0,1,1]
    v_pk_fma_f32 v[132:133], v[24:25], v[42:43], v[70:71] op_sel_hi:[0,1,1]
    v_pk_fma_f32 v[136:137], v[24:25], v[44:45], v[72:73] op_sel_hi:[0,1,1]
    v_pk_fma_f32 v[140:141], v[24:25], v[46:47], v[74:75] op_sel_hi:[0,1,1]
    v_pk_fma_f32 v[144:145], v[24:25], v[48:49], v[76:77] op_sel_hi:[0,1,1]
    v_pk_fma_f32 v[148:149], v[24:25], v[50:51], v[78:79] op_sel_hi:[0,1,1]
    v_pk_fma_f32 v[152:153], v[24:25], v[52:53], v[80:81] op_sel_hi:[0,1,1]
    v_pk_mul_f32 v[130:131], v[128:129], v[128:129]
    v_pk_mul_f32 v[134:135], v[132:133], v[132:133]
    v_pk_mul_f32 v[138:139], v[136:137], v[136:137]
    v_pk_mul_f32 v[142:143], v[140:141], v[140:141]
    v_pk_mul_f32 v[146:147], v[144:145], v[144:145]
    v_pk_mul_f32 v[150:151], v[148:149], v[148:149]
    v_pk_mul_f32 v[154:155], v[152:153], v[152:153]
    v_pk_fma_f32 v[130:131], v[130:131], v[124:125], v[126:127]
    v_pk_fma_f32 v[134:135], v[134:135], v[124:125], v[126:127]
    v_pk_fma_f32 v[138:139], v[138:139], v[124:125], v[126:127]
    v_pk_fma_f32 v[142:143], v[142:143], v[124:125], v[126:127]
    v_pk_fma_f32 v[146:147], v[146:147], v[124:125], v[126:127]
    v_pk_fma_f32 v[150:151], v[150:151], v[124:125], v[126:127]
    v_pk_fma_f32 v[154:155], v[154:155], v[124:125], v[126:127]
    v_pk_mul_f32 v[130:131], v[130:131], v[128:129]
    v_pk_mul_f32 v[134:135], v[134:135], v[132:133]
    v_pk_mul_f32 v[138:139], v[138:139], v[136:137]
    v_pk_mul_f32 v[142:143], v[142:143], v[140:141]
    v_pk_mul_f32 v[146:147], v[146:147], v[144:145]
    v_pk_mul_f32 v[150:151], v[150:151], v[148:149]
    v_pk_mul_f32 v[154:155], v[154:155], v[152:153]
    v_exp_f32 v130, v130
    v_exp_f32 v131, v131
    v_exp_f32 v134, v134
    v_exp_f32 v135, v135
    v_exp_f32 v138, v138
    v_exp_f32 v139, v139
    v_exp_f32 v142, v142
    v_exp_f32 v143, v143
    v_exp_f32 v146, v146
    v_exp_f32 v147, v147
    v_exp_f32 v150, v150
    v_exp_f32 v151, v151
    v_exp_f32 v154, v154
    v_exp_f32 v155, v155
    v_pk_mul_f32 v[128:129], v[128:129], v[96:97]
    v_pk_mul_f32 v[132:133], v[132:133], v[98:99]
    v_pk_mul_f32 v[136:137], v[136:137], v[100:101]
    v_pk_mul_f32 v[140:141], v[140:141], v[102:103]
    v_pk_mul_f32 v[144:145], v[144:145], v[104:105]
    v_pk_mul_f32 v[148:149], v[148:149], v[106:107]
    v_pk_mul_f32 v[152:153], v[152:153], v[108:109]
    v_pk_add_f32 v[130:131], v[130:131], 1.0 op_sel_hi:[1,0]
    v_pk_add_f32 v[134:135], v[134:135], 1.0 op_sel_hi:[1,0]
    v_pk_add_f32 v[138:139], v[138:139], 1.0 op_sel_hi:[1,0]
    v_pk_add_f32 v[142:143], v[142:143], 1.0 op_sel_hi:[1,0]
    v_pk_add_f32 v[146:147], v[146:147], 1.0 op_sel_hi:[1,0]
    v_pk_add_f32 v[150:151], v[150:151], 1.0 op_sel_hi:[1,0]
    v_pk_add_f32 v[154:155], v[154:155], 1.0 op_sel_hi:[1,0]
    v_rcp_f32 v130, v130
    v_rcp_f32 v131, v131
    v_rcp_f32 v134, v134
    v_rcp_f32 v135, v135
    v_rcp_f32 v138, v138
    v_rcp_f32 v139, v139
    v_rcp_f32 v142, v142
    v_rcp_f32 v143, v143
    v_rcp_f32 v146, v146
    v_rcp_f32 v147, v147
    v_rcp_f32 v150, v150
    v_rcp_f32 v151, v151
    v_rcp_f32 v154, v154
    v_rcp_f32 v155, v155
    v_pk_fma_f32 v[22:23], v[128:129], v[130:131], v[22:23]
    v_pk_fma_f32 v[22:23], v[132:133], v[134:135], v[22:23]
    v_pk_fma_f32 v[22:23], v[136:137], v[138:139], v[22:23]
    v_pk_fma_f32 v[22:23], v[140:141], v[142:143], v[22:23]
    v_pk_fma_f32 v[22:23], v[144:145], v[146:147], v[22:23]
    v_pk_fma_f32 v[22:23], v[148:149], v[150:151], v[22:23]
    v_pk_fma_f32 v[22:23], v[152:153], v[154:155], v[22:23]
    v_pk_fma_f32 v[128:129], v[24:25], v[54:55], v[82:83] op_sel_hi:[0,1,1]
    v_pk_fma_f32 v[132:133], v[24:25], v[56:57], v[84:85] op_sel_hi:[0,1,1]
    v_pk_fma_f32 v[136:137], v[24:25], v[58:59], v[86:87] op_sel_hi:[0,1,1]
    v_pk_fma_f32 v[140:141], v[24:25], v[60:61], v[88:89] op_sel_hi:[0,1,1]
    v_pk_fma_f32 v[144:145], v[24:25], v[62:63], v[90:91] op_sel_hi:[0,1,1]
    v_pk_fma_f32 v[148:149], v[24:25], v[64:65], v[92:93] op_sel_hi:[0,1,1]
    v_pk_fma_f32 v[152:153], v[24:25], v[66:67], v[94:95] op_sel_hi:[0,1,1]
    v_pk_mul_f32 v[130:131], v[128:129], v[128:129]
    v_pk_mul_f32 v[134:135], v[132:133], v[132:133]
    v_pk_mul_f32 v[138:139], v[136:137], v[136:137]
    v_pk_mul_f32 v[142:143], v[140:141], v[140:141]
    v_pk_mul_f32 v[146:147], v[144:145], v[144:145]
    v_pk_mul_f32 v[150:151], v[148:149], v[148:149]
    v_pk_mul_f32 v[154:155], v[152:153], v[152:153]
    v_pk_fma_f32 v[130:131], v[130:131], v[124:125], v[126:127]
    v_pk_fma_f32 v[134:135], v[134:135], v[124:125], v[126:127]
    v_pk_fma_f32 v[138:139], v[138:139], v[124:125], v[126:127]
    v_pk_fma_f32 v[142:143], v[142:143], v[124:125], v[126:127]
    v_pk_fma_f32 v[146:147], v[146:147], v[124:125], v[126:127]
    v_pk_fma_f32 v[150:151], v[150:151], v[124:125], v[126:127]
    v_pk_fma_f32 v[154:155], v[154:155], v[124:125], v[126:127]
    v_pk_mul_f32 v[130:131], v[130:131], v[128:129]
    v_pk_mul_f32 v[134:135], v[134:135], v[132:133]
    v_pk_mul_f32 v[138:139], v[138:139], v[136:137]
    v_pk_mul_f32 v[142:143], v[142:143], v[140:141]
    v_pk_mul_f32 v[146:147], v[146:147], v[144:145]
    v_pk_mul_f32 v[150:151], v[150:151], v[148:149]
    v_pk_mul_f32 v[154:155], v[154:155], v[152:153]
    v_exp_f32 v130, v130
    v_exp_f32 v131, v131
    v_exp_f32 v134, v134
    v_exp_f32 v135, v135
    v_exp_f32 v138, v138
    v_exp_f32 v139, v139
    v_exp_f32 v142, v142
    v_exp_f32 v143, v143
    v_exp_f32 v146, v146
    v_exp_f32 v147, v147
    v_exp_f32 v150, v150
    v_exp_f32 v151, v151
    v_exp_f32 v154, v154
    v_exp_f32 v155, v155
    v_pk_mul_f32 v[128:129], v[128:129], v[110:111]
    v_pk_mul_f32 v[132:133], v[132:133], v[112:113]
    v_pk_mul_f32 v[136:137], v[136:137], v[114:115]
    v_pk_mul_f32 v[140:141], v[140:141], v[116:117]
    v_pk_mul_f32 v[144:145], v[144:145], v[118:119]
    v_pk_mul_f32 v[148:149], v[148:149], v[120:121]
    v_pk_mul_f32 v[152:153], v[152:153], v[122:123]
    v_pk_add_f32 v[130:131], v[130:131], 1.0 op_sel_hi:[1,0]
    v_pk_add_f32 v[134:135], v[134:135], 1.0 op_sel_hi:[1,0]
    v_pk_add_f32 v[138:139], v[138:139], 1.0 op_sel_hi:[1,0]
    v_pk_add_f32 v[142:143], v[142:143], 1.0 op_sel_hi:[1,0]
    v_pk_add_f32 v[146:147], v[146:147], 1.0 op_sel_hi:[1,0]
    v_pk_add_f32 v[150:151], v[150:151], 1.0 op_sel_hi:[1,0]
    v_pk_add_f32 v[154:155], v[154:155], 1.0 op_sel_hi:[1,0]
    v_rcp_f32 v130, v130
    v_rcp_f32 v131, v131
    v_rcp_f32 v134, v134
    v_rcp_f32 v135, v135
    v_rcp_f32 v138, v138
    v_rcp_f32 v139, v139
    v_rcp_f32 v142, v142
    v_rcp_f32 v143, v143
    v_rcp_f32 v146, v146
    v_rcp_f32 v147, v147
    v_rcp_f32 v150, v150
    v_rcp_f32 v151, v151
    v_rcp_f32 v154, v154
    v_rcp_f32 v155, v155
    v_pk_fma_f32 v[22:23], v[128:129], v[130:131], v[22:23]
    v_pk_fma_f32 v[22:23], v[132:133], v[134:135], v[22:23]
    v_pk_fma_f32 v[22:23], v[136:137], v[138:139], v[22:23]
    v_pk_fma_f32 v[22:23], v[140:141], v[142:143], v[22:23]
    v_pk_fma_f32 v[22:23], v[144:145], v[146:147], v[22:23]
    v_pk_fma_f32 v[22:23], v[148:149], v[150:151], v[22:23]
    v_pk_fma_f32 v[22:23], v[152:153], v[154:155], v[22:23]
    v_add_f32 v22, v22, v23
    s_nop 1
    v_add_f32_dpp v22, v22, v22 quad_perm:[1,0,3,2] row_mask:0xf bank_mask:0xf
    s_nop 1
    v_add_f32_dpp v22, v22, v22 quad_perm:[2,3,0,1] row_mask:0xf bank_mask:0xf
    s_nop 1
    v_add_f32_dpp v22, v22, v22 row_half_mirror row_mask:0xf bank_mask:0xf
    s_nop 1
    v_add_f32_dpp v22, v22, v22 row_mirror row_mask:0xf bank_mask:0xf
    v_mov_b32 v23, v22
    s_nop 1
    v_permlane16_swap_b32 v22, v23
    v_add_f32 v22, v22, v23
    v_mov_b32 v23, v22
    s_nop 1
    v_permlane32_swap_b32 v22, v23
    v_add_f32 v22, v22, v23
    v_cvt_pk_bf16_f32 v22, v22, v22
    v_and_b32 v22, 0xffff0000, v22
    v_add_f32 v22, v22, v39
    v_cvt_pk_bf16_f32 v22, v22, v22
    v_and_b32 v22, 0xffff0000, v22
    s_nop 0
    v_readfirstlane_b32 s54, v22
    s_mov_b32 m0, s53
    s_nop 3
    v_writelane_b32 v20, s54, m0
    s_cmp_lg_u64 s[40:41], 0
    s_cbranch_scc1 L_fb_loop
    s_branch L_fb_done
L_helper:
    v_mov_b32 v15, 0
    s_load_dword s61, s[28:29], 327680
    s_load_dword s46, s[22:23], 0
    v_mov_b32 v12, 1
    s_waitcnt vmcnt(4)
    s_mov_b64 exec, 1
    ds_add_u32 v15, v12 offset:12
    s_mov_b64 exec, -1
    s_mov_b32 s36, s12
    s_mov_b32 s37, s13
    s_mov_b32 s38, 3670016
    s_mov_b32 s39, 0x20000
    v_lshrrev_b32 v2, 3, v1
    v_mul_u32_u24 v3, 896, v2
    v_and_b32 v4, 1, v1
    v_lshl_add_u32 v3, v4, 4, v3
    v_bfe_u32 v4, v1, 4, 1
    v_bfe_u32 v5, v1, 1, 2
    v_sub_u32 v5, v5, v4
    v_subrev_u32 v6, 0, v5
    v_and_b32 v6, 3, v6
    v_lshl_add_u32 v10, v6, 5, v3
    v_subrev_u32 v6, 2, v5
    v_and_b32 v6, 3, v6
    v_lshl_add_u32 v11, v6, 5, v3
    s_mul_i32 s52, s35, 24
    s_mul_i32 s53, s30, 8
    s_add_u32 s52, s52, s53
    s_cmp_ge_u32 s52, 3072
    s_cselect_b32 s53, 29696, 0
    s_add_u32 s52, s52, s53
    s_add_u32 s52, s52, 13824
    s_lshl_b32 s52, s52, 16
    s_add_u32 s53, s52, 0
    v_mov_b32 v104, s53
    v_mov_b32 v120, 0
    v_mov_b32 v121, 0
    s_add_u32 s53, s52, 65536
    v_mov_b32 v106, s53
    v_mov_b32 v122, 0
    v_mov_b32 v123, 0
    s_add_u32 s53, s52, 131072
    v_mov_b32 v108, s53
    v_mov_b32 v124, 0
    v_mov_b32 v125, 0
    s_add_u32 s53, s52, 196608
    v_mov_b32 v110, s53
    v_mov_b32 v126, 0
    v_mov_b32 v127, 0
    s_add_u32 s53, s52, 262144
    v_mov_b32 v112, s53
    v_mov_b32 v128, 0
    v_mov_b32 v129, 0
    s_add_u32 s53, s52, 327680
    v_mov_b32 v114, s53
    v_mov_b32 v130, 0
    v_mov_b32 v131, 0
    s_add_u32 s53, s52, 393216
    v_mov_b32 v116, s53
    v_mov_b32 v132, 0
    v_mov_b32 v133, 0
    s_add_u32 s53, s52, 458752
    v_mov_b32 v118, s53
    v_mov_b32 v134, 0
    v_mov_b32 v135, 0
    v_mov_b32 v100, 0xbdd2d3e8
    v_mov_b32 v101, 0xbdd2d3e8
    v_mov_b32 v102, 0xc0135761
    v_mov_b32 v103, 0xc0135761
    s_waitcnt vmcnt(0)
    s_mov_b64 exec, 1
    ds_add_u32 v15, v12 offset:8
    s_mov_b64 exec, -1
    s_mov_b32 s60, 0
    s_branch L_pcf_10
L_pc_11:
    s_sleep 1
L_pcf_10:
    ds_read_b32 v12, v15 offset:8
    s_waitcnt lgkmcnt(0)
    v_cmp_ne_u32 vcc, 3, v12
    s_cbranch_vccz L_out_12
    s_add_u32 s60, s60, 1
    s_cmp_le_u32 s60, 200000
    s_cbranch_scc1 L_pc_11
L_out_12:
    s_add_u32 s61, s61, 1
    s_lshl_b32 s46, s46, 16
    v_mov_b32 v13, s46
    ds_write_b32 v15, v13 offset:28
    s_setprio 2
    v_lshlrev_b32 v12, 3, v1
    ds_read_b64 v[136:137], v12 offset:8192
    ds_read_b64 v[138:139], v12 offset:8704
    ds_read_b64 v[140:141], v12 offset:9216
    ds_read_b64 v[142:143], v12 offset:9728
    ds_read_b64 v[144:145], v12 offset:10240
    ds_read_b64 v[146:147], v12 offset:10752
    ds_read_b64 v[148:149], v12 offset:11264
    s_waitcnt lgkmcnt(0)
    v_lshlrev_b32 v16, 16, v136
    v_and_b32 v17, 0xffff0000, v136
    v_lshlrev_b32 v18, 16, v137
    v_and_b32 v19, 0xffff0000, v137
    v_lshlrev_b32 v20, 16, v138
    v_and_b32 v21, 0xffff0000, v138
    v_lshlrev_b32 v22, 16, v139
    v_and_b32 v23, 0xffff0000, v139
    v_lshlrev_b32 v24, 16, v140
    v_and_b32 v25, 0xffff0000, v140
    v_lshlrev_b32 v26, 16, v141
    v_and_b32 v27, 0xffff0000, v141
    v_lshlrev_b32 v28, 16, v142
    v_and_b32 v29, 0xffff0000, v142
    v_lshlrev_b32 v30, 16, v143
    v_and_b32 v31, 0xffff0000, v143
    v_lshlrev_b32 v32, 16, v144
    v_and_b32 v33, 0xffff0000, v144
    v_lshlrev_b32 v34, 16, v145
    v_and_b32 v35, 0xffff0000, v145
    v_lshlrev_b32 v36, 16, v146
    v_and_b32 v37, 0xffff0000, v146
    v_lshlrev_b32 v38, 16, v147
    v_and_b32 v39, 0xffff0000, v147
    v_lshlrev_b32 v40, 16, v148
    v_and_b32 v41, 0xffff0000, v148
    v_lshlrev_b32 v42, 16, v149
    v_and_b32 v43, 0xffff0000, v149
    ds_read_b64 v[136:137], v12 offset:12288
    ds_read_b64 v[138:139], v12 offset:12800
    ds_read_b64 v[140:141], v12 offset:13312
    ds_read_b64 v[142:143], v12 offset:13824
    ds_read_b64 v[144:145], v12 offset:14336
    ds_read_b64 v[146:147], v12 offset:14848
    ds_read_b64 v[148:149], v12 offset:15360
    s_waitcnt lgkmcnt(0)
    v_lshlrev_b32 v44, 16, v136
    v_and_b32 v45, 0xffff0000, v136
    v_lshlrev_b32 v46, 16, v137
    v_and_b32 v47, 0xffff0000, v137
    v_lshlrev_b32 v48, 16, v138
    v_and_b32 v49, 0xffff0000, v138
    v_lshlrev_b32 v50, 16, v139
    v_and_b32 v51, 0xffff0000, v139
    v_lshlrev_b32 v52, 16, v140
    v_and_b32 v53, 0xffff0000, v140
    v_lshlrev_b32 v54, 16, v141
    v_and_b32 v55, 0xffff0000, v141
    v_lshlrev_b32 v56, 16, v142
    v_and_b32 v57, 0xffff0000, v142
    v_lshlrev_b32 v58, 16, v143
    v_and_b32 v59, 0xffff0000, v143
    v_lshlrev_b32 v60, 16, v144
    v_and_b32 v61, 0xffff0000, v144
    v_lshlrev_b32 v62, 16, v145
    v_and_b32 v63, 0xffff0000, v145
    v_lshlrev_b32 v64, 16, v146
    v_and_b32 v65, 0xffff0000, v146
    v_lshlrev_b32 v66, 16, v147
    v_and_b32 v67, 0xffff0000, v147
    v_lshlrev_b32 v68, 16, v148
    v_and_b32 v69, 0xffff0000, v148
    v_lshlrev_b32 v70, 16, v149
    v_and_b32 v71, 0xffff0000, v149
    ds_read_b64 v[136:137], v12 offset:16384
    ds_read_b64 v[138:139], v12 offset:16896
    ds_read_b64 v[140:141], v12 offset:17408
    ds_read_b64 v[142:143], v12 offset:17920
    ds_read_b64 v[144:145], v12 offset:18432
    ds_read_b64 v[146:147], v12 offset:18944
    ds_read_b64 v[148:149], v12 offset:19456
    s_waitcnt lgkmcnt(0)
    v_lshlrev_b32 v72, 16, v136
    v_and_b32 v73, 0xffff0000, v136
    v_lshlrev_b32 v74, 16, v137
    v_and_b32 v75, 0xffff0000, v137
    v_lshlrev_b32 v76, 16, v138
    v_and_b32 v77, 0xffff0000, v138
    v_lshlrev_b32 v78, 16, v139
    v_and_b32 v79, 0xffff0000, v139
    v_lshlrev_b32 v80, 16, v140
    v_and_b32 v81, 0xffff0000, v140
    v_lshlrev_b32 v82, 16, v141
    v_and_b32 v83, 0xffff0000, v141
    v_lshlrev_b32 v84, 16, v142
    v_and_b32 v85, 0xffff0000, v142
    v_lshlrev_b32 v86, 16, v143
    v_and_b32 v87, 0xffff0000, v143
    v_lshlrev_b32 v88, 16, v144
    v_and_b32 v89, 0xffff0000, v144
    v_lshlrev_b32 v90, 16, v145
    v_and_b32 v91, 0xffff0000, v145
    v_lshlrev_b32 v92, 16, v146
    v_and_b32 v93, 0xffff0000, v146
    v_lshlrev_b32 v94, 16, v147
    v_and_b32 v95, 0xffff0000, v147
    v_lshlrev_b32 v96, 16, v148
    v_and_b32 v97, 0xffff0000, v148
    v_lshlrev_b32 v98, 16, v149
    v_and_b32 v99, 0xffff0000, v149
    v_pk_fma_f32 v[136:137], v[104:105], v[16:17], v[44:45] op_sel_hi:[0,1,1]
    v_pk_fma_f32 v[140:141], v[106:107], v[16:17], v[44:45] op_sel_hi:[0,1,1]
    v_pk_fma_f32 v[144:145], v[108:109], v[16:17], v[44:45] op_sel_hi:[0,1,1]
    v_pk_fma_f32 v[148:149], v[110:111], v[16:17], v[44:45] op_sel_hi:[0,1,1]
    v_pk_fma_f32 v[152:153], v[112:113], v[16:17], v[44:45] op_sel_hi:[0,1,1]
    v_pk_fma_f32 v[156:157], v[114:115], v[16:17], v[44:45] op_sel_hi:[0,1,1]
    v_pk_fma_f32 v[160:161], v[116:117], v[16:17], v[44:45] op_sel_hi:[0,1,1]
    v_pk_fma_f32 v[164:165], v[118:119], v[16:17], v[44:45] op_sel_hi:[0,1,1]
    v_pk_mul_f32 v[138:139], v[136:137], v[136:137]
    v_pk_mul_f32 v[142:143], v[140:141], v[140:141]
    v_pk_mul_f32 v[146:147], v[144:145], v[144:145]
    v_pk_mul_f32 v[150:151], v[148:149], v[148:149]
    v_pk_mul_f32 v[154:155], v[152:153], v[152:153]
    v_pk_mul_f32 v[158:159], v[156:157], v[156:157]
    v_pk_mul_f32 v[162:163], v[160:161], v[160:161]
    v_pk_mul_f32 v[166:167], v[164:165], v[164:165]
    v_pk_fma_f32 v[138:139], v[138:139], v[100:101], v[102:103]
    v_pk_fma_f32 v[142:143], v[142:143], v[100:101], v[102:103]
    v_pk_fma_f32 v[146:147], v[146:147], v[100:101], v[102:103]
    v_pk_fma_f32 v[150:151], v[150:151], v[100:101], v[102:103]
    v_pk_fma_f32 v[154:155], v[154:155], v[100:101], v[102:103]
    v_pk_fma_f32 v[158:159], v[158:159], v[100:101], v[102:103]
    v_pk_fma_f32 v[162:163], v[162:163], v[100:101], v[102:103]
    v_pk_fma_f32 v[166:167], v[166:167], v[100:101], v[102:103]
    v_pk_mul_f32 v[138:139], v[138:139], v[136:137]
    v_pk_mul_f32 v[142:143], v[142:143], v[140:141]
    v_pk_mul_f32 v[146:147], v[146:147], v[144:145]
    v_pk_mul_f32 v[150:151], v[150:151], v[148:149]
    v_pk_mul_f32 v[154:155], v[154:155], v[152:153]
    v_pk_mul_f32 v[158:159], v[158:159], v[156:157]
    v_pk_mul_f32 v[162:163], v[162:163], v[160:161]
    v_pk_mul_f32 v[166:167], v[166:167], v[164:165]
    v_exp_f32 v138, v138
    v_exp_f32 v139, v139
    v_exp_f32 v142, v142
    v_exp_f32 v143, v143
    v_exp_f32 v146, v146
    v_exp_f32 v147, v147
    v_exp_f32 v150, v150
    v_exp_f32 v151, v151
    v_exp_f32 v154, v154
    v_exp_f32 v155, v155
    v_exp_f32 v158, v158
    v_exp_f32 v159, v159
    v_exp_f32 v162, v162
    v_exp_f32 v163, v163
    v_exp_f32 v166, v166
    v_exp_f32 v167, v167
    v_pk_mul_f32 v[136:137], v[136:137], v[72:73]
    v_pk_mul_f32 v[140:141], v[140:141], v[72:73]
    v_pk_mul_f32 v[144:145], v[144:145], v[72:73]
    v_pk_mul_f32 v[148:149], v[148:149], v[72:73]
    v_pk_mul_f32 v[152:153], v[152:153], v[72:73]
    v_pk_mul_f32 v[156:157], v[156:157], v[72:73]
    v_pk_mul_f32 v[160:161], v[160:161], v[72:73]
    v_pk_mul_f32 v[164:165], v[164:165], v[72:73]
    v_pk_add_f32 v[138:139], v[138:139], 1.0 op_sel_hi:[1,0]
    v_pk_add_f32 v[142:143], v[142:143], 1.0 op_sel_hi:[1,0]
    v_pk_add_f32 v[146:147], v[146:147], 1.0 op_sel_hi:[1,0]
    v_pk_add_f32 v[150:151], v[150:151], 1.0 op_sel_hi:[1,0]
    v_pk_add_f32 v[154:155], v[154:155], 1.0 op_sel_hi:[1,0]
    v_pk_add_f32 v[158:159], v[158:159], 1.0 op_sel_hi:[1,0]
    v_pk_add_f32 v[162:163], v[162:163], 1.0 op_sel_hi:[1,0]
    v_pk_add_f32 v[166:167], v[166:167], 1.0 op_sel_hi:[1,0]
    v_rcp_f32 v138, v138
    v_rcp_f32 v139, v139
    v_rcp_f32 v142, v142
    v_rcp_f32 v143, v143
    v_rcp_f32 v146, v146
    v_rcp_f32 v147, v147
    v_rcp_f32 v150, v150
    v_rcp_f32 v151, v151
    v_rcp_f32 v154, v154
    v_rcp_f32 v155, v155
    v_rcp_f32 v158, v158
    v_rcp_f32 v159, v159
    v_rcp_f32 v162, v162
    v_rcp_f32 v163, v163
    v_rcp_f32 v166, v166
    v_rcp_f32 v167, v167
    v_pk_fma_f32 v[120:121], v[136:137], v[138:139], v[120:121]
    v_pk_fma_f32 v[122:123], v[140:141], v[142:143], v[122:123]
    v_pk_fma_f32 v[124:125], v[144:145], v[146:147], v[124:125]
    v_pk_fma_f32 v[126:127], v[148:149], v[150:151], v[126:127]
    v_pk_fma_f32 v[128:129], v[152:153], v[154:155], v[128:129]
    v_pk_fma_f32 v[130:131], v[156:157], v[158:159], v[130:131]
    v_pk_fma_f32 v[132:133], v[160:161], v[162:163], v[132:133]
    v_pk_fma_f32 v[134:135], v[164:165], v[166:167], v[134:135]
    v_pk_fma_f32 v[136:137], v[104:105], v[18:19], v[46:47] op_sel_hi:[0,1,1]
    v_pk_fma_f32 v[140:141], v[106:107], v[18:19], v[46:47] op_sel_hi:[0,1,1]
    v_pk_fma_f32 v[144:145], v[108:109], v[18:19], v[46:47] op_sel_hi:[0,1,1]
    v_pk_fma_f32 v[148:149], v[110:111], v[18:19], v[46:47] op_sel_hi:[0,1,1]
    v_pk_fma_f32 v[152:153], v[112:113], v[18:19], v[46:47] op_sel_hi:[0,1,1]
    v_pk_fma_f32 v[156:157], v[114:115], v[18:19], v[46:47] op_sel_hi:[0,1,1]
    v_pk_fma_f32 v[160:161], v[116:117], v[18:19], v[46:47] op_sel_hi:[0,1,1]
    v_pk_fma_f32 v[164:165], v[118:119], v[18:19], v[46:47] op_sel_hi:[0,1,1]
    v_pk_mul_f32 v[138:139], v[136:137], v[136:137]
    v_pk_mul_f32 v[142:143], v[140:141], v[140:141]
    v_pk_mul_f32 v[146:147], v[144:145], v[144:145]
    v_pk_mul_f32 v[150:151], v[148:149], v[148:149]
    v_pk_mul_f32 v[154:155], v[152:153], v[152:153]
    v_pk_mul_f32 v[158:159], v[156:157], v[156:157]
    v_pk_mul_f32 v[162:163], v[160:161], v[160:161]
    v_pk_mul_f32 v[166:167], v[164:165], v[164:165]
    v_pk_fma_f32 v[138:139], v[138:139], v[100:101], v[102:103]
    v_pk_fma_f32 v[142:143], v[142:143], v[100:101], v[102:103]
    v_pk_fma_f32 v[146:147], v[146:147], v[100:101], v[102:103]
    v_pk_fma_f32 v[150:151], v[150:151], v[100:101], v[102:103]
    v_pk_fma_f32 v[154:155], v[154:155], v[100:101], v[102:103]
    v_pk_fma_f32 v[158:159], v[158:159], v[100:101], v[102:103]
    v_pk_fma_f32 v[162:163], v[162:163], v[100:101], v[102:103]
    v_pk_fma_f32 v[166:167], v[166:167], v[100:101], v[102:103]
    v_pk_mul_f32 v[138:139], v[138:139], v[136:137]
    v_pk_mul_f32 v[142:143], v[142:143], v[140:141]
    v_pk_mul_f32 v[146:147], v[146:147], v[144:145]
    v_pk_mul_f32 v[150:151], v[150:151], v[148:149]
    v_pk_mul_f32 v[154:155], v[154:155], v[152:153]
    v_pk_mul_f32 v[158:159], v[158:159], v[156:157]
    v_pk_mul_f32 v[162:163], v[162:163], v[160:161]
    v_pk_mul_f32 v[166:167], v[166:167], v[164:165]
    v_exp_f32 v138, v138
    v_exp_f32 v139, v139
    v_exp_f32 v142, v142
    v_exp_f32 v143, v143
    v_exp_f32 v146, v146
    v_exp_f32 v147, v147
    v_exp_f32 v150, v150
    v_exp_f32 v151, v151
    v_exp_f32 v154, v154
    v_exp_f32 v155, v155
    v_exp_f32 v158, v158
    v_exp_f32 v159, v159
    v_exp_f32 v162, v162
    v_exp_f32 v163, v163
    v_exp_f32 v166, v166
    v_exp_f32 v167, v167
    v_pk_mul_f32 v[136:137], v[136:137], v[74:75]
    v_pk_mul_f32 v[140:141], v[140:141], v[74:75]
    v_pk_mul_f32 v[144:145], v[144:145], v[74:75]
    v_pk_mul_f32 v[148:149], v[148:149], v[74:75]
    v_pk_mul_f32 v[152:153], v[152:153], v[74:75]
    v_pk_mul_f32 v[156:157], v[156:157], v[74:75]
    v_pk_mul_f32 v[160:161], v[160:161], v[74:75]
    v_pk_mul_f32 v[164:165], v[164:165], v[74:75]
    v_pk_add_f32 v[138:139], v[138:139], 1.0 op_sel_hi:[1,0]
    v_pk_add_f32 v[142:143], v[142:143], 1.0 op_sel_hi:[1,0]
    v_pk_add_f32 v[146:147], v[146:147], 1.0 op_sel_hi:[1,0]
    v_pk_add_f32 v[150:151], v[150:151], 1.0 op_sel_hi:[1,0]
    v_pk_add_f32 v[154:155], v[154:155], 1.0 op_sel_hi:[1,0]
    v_pk_add_f32 v[158:159], v[158:159], 1.0 op_sel_hi:[1,0]
    v_pk_add_f32 v[162:163], v[162:163], 1.0 op_sel_hi:[1,0]
    v_pk_add_f32 v[166:167], v[166:167], 1.0 op_sel_hi:[1,0]
    v_rcp_f32 v138, v138
    v_rcp_f32 v139, v139
    v_rcp_f32 v142, v142
    v_rcp_f32 v143, v143
    v_rcp_f32 v146, v146
    v_rcp_f32 v147, v147
    v_rcp_f32 v150, v150
    v_rcp_f32 v151, v151
    v_rcp_f32 v154, v154
    v_rcp_f32 v155, v155
    v_rcp_f32 v158, v158
    v_rcp_f32 v159, v159
    v_rcp_f32 v162, v162
    v_rcp_f32 v163, v163
    v_rcp_f32 v166, v166
    v_rcp_f32 v167, v167
    v_pk_fma_f32 v[120:121], v[136:137], v[138:139], v[120:121]
    v_pk_fma_f32 v[122:123], v[140:141], v[142:143], v[122:123]
    v_pk_fma_f32 v[124:125], v[144:145], v[146:147], v[124:125]
    v_pk_fma_f32 v[126:127], v[148:149], v[150:151], v[126:127]
    v_pk_fma_f32 v[128:129], v[152:153], v[154:155], v[128:129]
    v_pk_fma_f32 v[130:131], v[156:157], v[158:159], v[130:131]
    v_pk_fma_f32 v[132:133], v[160:161], v[162:163], v[132:133]
    v_pk_fma_f32 v[134:135], v[164:165], v[166:167], v[134:135]
    v_pk_fma_f32 v[136:137], v[104:105], v[20:21], v[48:49] op_sel_hi:[0,1,1]
    v_pk_fma_f32 v[140:141], v[106:107], v[20:21], v[48:49] op_sel_hi:[0,1,1]
    v_pk_fma_f32 v[144:145], v[108:109], v[20:21], v[48:49] op_sel_hi:[0,1,1]
    v_pk_fma_f32 v[148:149], v[110:111], v[20:21], v[48:49] op_sel_hi:[0,1,1]
    v_pk_fma_f32 v[152:153], v[112:113], v[20:21], v[48:49] op_sel_hi:[0,1,1]
    v_pk_fma_f32 v[156:157], v[114:115], v[20:21], v[48:49] op_sel_hi:[0,1,1]
    v_pk_fma_f32 v[160:161], v[116:117], v[20:21], v[48:49] op_sel_hi:[0,1,1]
    v_pk_fma_f32 v[164:165], v[118:119], v[20:21], v[48:49] op_sel_hi:[0,1,1]
    v_pk_mul_f32 v[138:139], v[136:137], v[136:137]
    v_pk_mul_f32 v[142:143], v[140:141], v[140:141]
    v_pk_mul_f32 v[146:147], v[144:145], v[144:145]
    v_pk_mul_f32 v[150:151], v[148:149], v[148:149]
    v_pk_mul_f32 v[154:155], v[152:153], v[152:153]
    v_pk_mul_f32 v[158:159], v[156:157], v[156:157]
    v_pk_mul_f32 v[162:163], v[160:161], v[160:161]
    v_pk_mul_f32 v[166:167], v[164:165], v[164:165]
    v_pk_fma_f32 v[138:139], v[138:139], v[100:101], v[102:103]
    v_pk_fma_f32 v[142:143], v[142:143], v[100:101], v[102:103]
    v_pk_fma_f32 v[146:147], v[146:147], v[100:101], v[102:103]
    v_pk_fma_f32 v[150:151], v[150:151], v[100:101], v[102:103]
    v_pk_fma_f32 v[154:155], v[154:155], v[100:101], v[102:103]
    v_pk_fma_f32 v[158:159], v[158:159], v[100:101], v[102:103]
    v_pk_fma_f32 v[162:163], v[162:163], v[100:101], v[102:103]
    v_pk_fma_f32 v[166:167], v[166:167], v[100:101], v[102:103]
    v_pk_mul_f32 v[138:139], v[138:139], v[136:137]
    v_pk_mul_f32 v[142:143], v[142:143], v[140:141]
    v_pk_mul_f32 v[146:147], v[146:147], v[144:145]
    v_pk_mul_f32 v[150:151], v[150:151], v[148:149]
    v_pk_mul_f32 v[154:155], v[154:155], v[152:153]
    v_pk_mul_f32 v[158:159], v[158:159], v[156:157]
    v_pk_mul_f32 v[162:163], v[162:163], v[160:161]
    v_pk_mul_f32 v[166:167], v[166:167], v[164:165]
    v_exp_f32 v138, v138
    v_exp_f32 v139, v139
    v_exp_f32 v142, v142
    v_exp_f32 v143, v143
    v_exp_f32 v146, v146
    v_exp_f32 v147, v147
    v_exp_f32 v150, v150
    v_exp_f32 v151, v151
    v_exp_f32 v154, v154
    v_exp_f32 v155, v155
    v_exp_f32 v158, v158
    v_exp_f32 v159, v159
    v_exp_f32 v162, v162
    v_exp_f32 v163, v163
    v_exp_f32 v166, v166
    v_exp_f32 v167, v167
    v_pk_mul_f32 v[136:137], v[136:137], v[76:77]
    v_pk_mul_f32 v[140:141], v[140:141], v[76:77]
    v_pk_mul_f32 v[144:145], v[144:145], v[76:77]
    v_pk_mul_f32 v[148:149], v[148:149], v[76:77]
    v_pk_mul_f32 v[152:153], v[152:153], v[76:77]
    v_pk_mul_f32 v[156:157], v[156:157], v[76:77]
    v_pk_mul_f32 v[160:161], v[160:161], v[76:77]
    v_pk_mul_f32 v[164:165], v[164:165], v[76:77]
    v_pk_add_f32 v[138:139], v[138:139], 1.0 op_sel_hi:[1,0]
    v_pk_add_f32 v[142:143], v[142:143], 1.0 op_sel_hi:[1,0]
    v_pk_add_f32 v[146:147], v[146:147], 1.0 op_sel_hi:[1,0]
    v_pk_add_f32 v[150:151], v[150:151], 1.0 op_sel_hi:[1,0]
    v_pk_add_f32 v[154:155], v[154:155], 1.0 op_sel_hi:[1,0]
    v_pk_add_f32 v[158:159], v[158:159], 1.0 op_sel_hi:[1,0]
    v_pk_add_f32 v[162:163], v[162:163], 1.0 op_sel_hi:[1,0]
    v_pk_add_f32 v[166:167], v[166:167], 1.0 op_sel_hi:[1,0]
    v_rcp_f32 v138, v138
    v_rcp_f32 v139, v139
    v_rcp_f32 v142, v142
    v_rcp_f32 v143, v143
    v_rcp_f32 v146, v146
    v_rcp_f32 v147, v147
    v_rcp_f32 v150, v150
    v_rcp_f32 v151, v151
    v_rcp_f32 v154, v154
    v_rcp_f32 v155, v155
    v_rcp_f32 v158, v158
    v_rcp_f32 v159, v159
    v_rcp_f32 v162, v162
    v_rcp_f32 v163, v163
    v_rcp_f32 v166, v166
    v_rcp_f32 v167, v167
    v_pk_fma_f32 v[120:121], v[136:137], v[138:139], v[120:121]
    v_pk_fma_f32 v[122:123], v[140:141], v[142:143], v[122:123]
    v_pk_fma_f32 v[124:125], v[144:145], v[146:147], v[124:125]
    v_pk_fma_f32 v[126:127], v[148:149], v[150:151], v[126:127]
    v_pk_fma_f32 v[128:129], v[152:153], v[154:155], v[128:129]
    v_pk_fma_f32 v[130:131], v[156:157], v[158:159], v[130:131]
    v_pk_fma_f32 v[132:133], v[160:161], v[162:163], v[132:133]
    v_pk_fma_f32 v[134:135], v[164:165], v[166:167], v[134:135]
    v_pk_fma_f32 v[136:137], v[104:105], v[22:23], v[50:51] op_sel_hi:[0,1,1]
    v_pk_fma_f32 v[140:141], v[106:107], v[22:23], v[50:51] op_sel_hi:[0,1,1]
    v_pk_fma_f32 v[144:145], v[108:109], v[22:23], v[50:51] op_sel_hi:[0,1,1]
    v_pk_fma_f32 v[148:149], v[110:111], v[22:23], v[50:51] op_sel_hi:[0,1,1]
    v_pk_fma_f32 v[152:153], v[112:113], v[22:23], v[50:51] op_sel_hi:[0,1,1]
    v_pk_fma_f32 v[156:157], v[114:115], v[22:23], v[50:51] op_sel_hi:[0,1,1]
    v_pk_fma_f32 v[160:161], v[116:117], v[22:23], v[50:51] op_sel_hi:[0,1,1]
    v_pk_fma_f32 v[164:165], v[118:119], v[22:23], v[50:51] op_sel_hi:[0,1,1]
    v_pk_mul_f32 v[138:139], v[136:137], v[136:137]
    v_pk_mul_f32 v[142:143], v[140:141], v[140:141]
    v_pk_mul_f32 v[146:147], v[144:145], v[144:145]
    v_pk_mul_f32 v[150:151], v[148:149], v[148:149]
    v_pk_mul_f32 v[154:155], v[152:153], v[152:153]
    v_pk_mul_f32 v[158:159], v[156:157], v[156:157]
    v_pk_mul_f32 v[162:163], v[160:161], v[160:161]
    v_pk_mul_f32 v[166:167], v[164:165], v[164:165]
    v_pk_fma_f32 v[138:139], v[138:139], v[100:101], v[102:103]
    v_pk_fma_f32 v[142:143], v[142:143], v[100:101], v[102:103]
    v_pk_fma_f32 v[146:147], v[146:147], v[100:101], v[102:103]
    v_pk_fma_f32 v[150:151], v[150:151], v[100:101], v[102:103]
    v_pk_fma_f32 v[154:155], v[154:155], v[100:101], v[102:103]
    v_pk_fma_f32 v[158:159], v[158:159], v[100:101], v[102:103]
    v_pk_fma_f32 v[162:163], v[162:163], v[100:101], v[102:103]
    v_pk_fma_f32 v[166:167], v[166:167], v[100:101], v[102:103]
    v_pk_mul_f32 v[138:139], v[138:139], v[136:137]
    v_pk_mul_f32 v[142:143], v[142:143], v[140:141]
    v_pk_mul_f32 v[146:147], v[146:147], v[144:145]
    v_pk_mul_f32 v[150:151], v[150:151], v[148:149]
    v_pk_mul_f32 v[154:155], v[154:155], v[152:153]
    v_pk_mul_f32 v[158:159], v[158:159], v[156:157]
    v_pk_mul_f32 v[162:163], v[162:163], v[160:161]
    v_pk_mul_f32 v[166:167], v[166:167], v[164:165]
    v_exp_f32 v138, v138
    v_exp_f32 v139, v139
    v_exp_f32 v142, v142
    v_exp_f32 v143, v143
    v_exp_f32 v146, v146
    v_exp_f32 v147, v147
    v_exp_f32 v150, v150
    v_exp_f32 v151, v151
    v_exp_f32 v154, v154
    v_exp_f32 v155, v155
    v_exp_f32 v158, v158
    v_exp_f32 v159, v159
    v_exp_f32 v162, v162
    v_exp_f32 v163, v163
    v_exp_f32 v166, v166
    v_exp_f32 v167, v167
    v_pk_mul_f32 v[136:137], v[136:137], v[78:79]
    v_pk_mul_f32 v[140:141], v[140:141], v[78:79]
    v_pk_mul_f32 v[144:145], v[144:145], v[78:79]
    v_pk_mul_f32 v[148:149], v[148:149], v[78:79]
    v_pk_mul_f32 v[152:153], v[152:153], v[78:79]
    v_pk_mul_f32 v[156:157], v[156:157], v[78:79]
    v_pk_mul_f32 v[160:161], v[160:161], v[78:79]
    v_pk_mul_f32 v[164:165], v[164:165], v[78:79]
    v_pk_add_f32 v[138:139], v[138:139], 1.0 op_sel_hi:[1,0]
    v_pk_add_f32 v[142:143], v[142:143], 1.0 op_sel_hi:[1,0]
    v_pk_add_f32 v[146:147], v[146:147], 1.0 op_sel_hi:[1,0]
    v_pk_add_f32 v[150:151], v[150:151], 1.0 op_sel_hi:[1,0]
    v_pk_add_f32 v[154:155], v[154:155], 1.0 op_sel_hi:[1,0]
    v_pk_add_f32 v[158:159], v[158:159], 1.0 op_sel_hi:[1,0]
    v_pk_add_f32 v[162:163], v[162:163], 1.0 op_sel_hi:[1,0]
    v_pk_add_f32 v[166:167], v[166:167], 1.0 op_sel_hi:[1,0]
    v_rcp_f32 v138, v138
    v_rcp_f32 v139, v139
    v_rcp_f32 v142, v142
    v_rcp_f32 v143, v143
    v_rcp_f32 v146, v146
    v_rcp_f32 v147, v147
    v_rcp_f32 v150, v150
    v_rcp_f32 v151, v151
    v_rcp_f32 v154, v154
    v_rcp_f32 v155, v155
    v_rcp_f32 v158, v158
    v_rcp_f32 v159, v159
    v_rcp_f32 v162, v162
    v_rcp_f32 v163, v163
    v_rcp_f32 v166, v166
    v_rcp_f32 v167, v167
    v_pk_fma_f32 v[120:121], v[136:137], v[138:139], v[120:121]
    v_pk_fma_f32 v[122:123], v[140:141], v[142:143], v[122:123]
    v_pk_fma_f32 v[124:125], v[144:145], v[146:147], v[124:125]
    v_pk_fma_f32 v[126:127], v[148:149], v[150:151], v[126:127]
    v_pk_fma_f32 v[128:129], v[152:153], v[154:155], v[128:129]
    v_pk_fma_f32 v[130:131], v[156:157], v[158:159], v[130:131]
    v_pk_fma_f32 v[132:133], v[160:161], v[162:163], v[132:133]
    v_pk_fma_f32 v[134:135], v[164:165], v[166:167], v[134:135]
    v_pk_fma_f32 v[136:137], v[104:105], v[24:25], v[52:53] op_sel_hi:[0,1,1]
    v_pk_fma_f32 v[140:141], v[106:107], v[24:25], v[52:53] op_sel_hi:[0,1,1]
    v_pk_fma_f32 v[144:145], v[108:109], v[24:25], v[52:53] op_sel_hi:[0,1,1]
    v_pk_fma_f32 v[148:149], v[110:111], v[24:25], v[52:53] op_sel_hi:[0,1,1]
    v_pk_fma_f32 v[152:153], v[112:113], v[24:25], v[52:53] op_sel_hi:[0,1,1]
    v_pk_fma_f32 v[156:157], v[114:115], v[24:25], v[52:53] op_sel_hi:[0,1,1]
    v_pk_fma_f32 v[160:161], v[116:117], v[24:25], v[52:53] op_sel_hi:[0,1,1]
    v_pk_fma_f32 v[164:165], v[118:119], v[24:25], v[52:53] op_sel_hi:[0,1,1]
    v_pk_mul_f32 v[138:139], v[136:137], v[136:137]
    v_pk_mul_f32 v[142:143], v[140:141], v[140:141]
    v_pk_mul_f32 v[146:147], v[144:145], v[144:145]
    v_pk_mul_f32 v[150:151], v[148:149], v[148:149]
    v_pk_mul_f32 v[154:155], v[152:153], v[152:153]
    v_pk_mul_f32 v[158:159], v[156:157], v[156:157]
    v_pk_mul_f32 v[162:163], v[160:161], v[160:161]
    v_pk_mul_f32 v[166:167], v[164:165], v[164:165]
    v_pk_fma_f32 v[138:139], v[138:139], v[100:101], v[102:103]
    v_pk_fma_f32 v[142:143], v[142:143], v[100:101], v[102:103]
    v_pk_fma_f32 v[146:147], v[146:147], v[100:101], v[102:103]
    v_pk_fma_f32 v[150:151], v[150:151], v[100:101], v[102:103]
    v_pk_fma_f32 v[154:155], v[154:155], v[100:101], v[102:103]
    v_pk_fma_f32 v[158:159], v[158:159], v[100:101], v[102:103]
    v_pk_fma_f32 v[162:163], v[162:163], v[100:101], v[102:103]
    v_pk_fma_f32 v[166:167], v[166:167], v[100:101], v[102:103]
    v_pk_mul_f32 v[138:139], v[138:139], v[136:137]
    v_pk_mul_f32 v[142:143], v[142:143], v[140:141]
    v_pk_mul_f32 v[146:147], v[146:147], v[144:145]
    v_pk_mul_f32 v[150:151], v[150:151], v[148:149]
    v_pk_mul_f32 v[154:155], v[154:155], v[152:153]
    v_pk_mul_f32 v[158:159], v[158:159], v[156:157]
    v_pk_mul_f32 v[162:163], v[162:163], v[160:161]
    v_pk_mul_f32 v[166:167], v[166:167], v[164:165]
    v_exp_f32 v138, v138
    v_exp_f32 v139, v139
    v_exp_f32 v142, v142
    v_exp_f32 v143, v143
    v_exp_f32 v146, v146
    v_exp_f32 v147, v147
    v_exp_f32 v150, v150
    v_exp_f32 v151, v151
    v_exp_f32 v154, v154
    v_exp_f32 v155, v155
    v_exp_f32 v158, v158
    v_exp_f32 v159, v159
    v_exp_f32 v162, v162
    v_exp_f32 v163, v163
    v_exp_f32 v166, v166
    v_exp_f32 v167, v167
    v_pk_mul_f32 v[136:137], v[136:137], v[80:81]
    v_pk_mul_f32 v[140:141], v[140:141], v[80:81]
    v_pk_mul_f32 v[144:145], v[144:145], v[80:81]
    v_pk_mul_f32 v[148:149], v[148:149], v[80:81]
    v_pk_mul_f32 v[152:153], v[152:153], v[80:81]
    v_pk_mul_f32 v[156:157], v[156:157], v[80:81]
    v_pk_mul_f32 v[160:161], v[160:161], v[80:81]
    v_pk_mul_f32 v[164:165], v[164:165], v[80:81]
    v_pk_add_f32 v[138:139], v[138:139], 1.0 op_sel_hi:[1,0]
    v_pk_add_f32 v[142:143], v[142:143], 1.0 op_sel_hi:[1,0]
    v_pk_add_f32 v[146:147], v[146:147], 1.0 op_sel_hi:[1,0]
    v_pk_add_f32 v[150:151], v[150:151], 1.0 op_sel_hi:[1,0]
    v_pk_add_f32 v[154:155], v[154:155], 1.0 op_sel_hi:[1,0]
    v_pk_add_f32 v[158:159], v[158:159], 1.0 op_sel_hi:[1,0]
    v_pk_add_f32 v[162:163], v[162:163], 1.0 op_sel_hi:[1,0]
    v_pk_add_f32 v[166:167], v[166:167], 1.0 op_sel_hi:[1,0]
    v_rcp_f32 v138, v138
    v_rcp_f32 v139, v139
    v_rcp_f32 v142, v142
    v_rcp_f32 v143, v143
    v_rcp_f32 v146, v146
    v_rcp_f32 v147, v147
    v_rcp_f32 v150, v150
    v_rcp_f32 v151, v151
    v_rcp_f32 v154, v154
    v_rcp_f32 v155, v155
    v_rcp_f32 v158, v158
    v_rcp_f32 v159, v159
    v_rcp_f32 v162, v162
    v_rcp_f32 v163, v163
    v_rcp_f32 v166, v166
    v_rcp_f32 v167, v167
    v_pk_fma_f32 v[120:121], v[136:137], v[138:139], v[120:121]
    v_pk_fma_f32 v[122:123], v[140:141], v[142:143], v[122:123]
    v_pk_fma_f32 v[124:125], v[144:145], v[146:147], v[124:125]
    v_pk_fma_f32 v[126:127], v[148:149], v[150:151], v[126:127]
    v_pk_fma_f32 v[128:129], v[152:153], v[154:155], v[128:129]
    v_pk_fma_f32 v[130:131], v[156:157], v[158:159], v[130:131]
    v_pk_fma_f32 v[132:133], v[160:161], v[162:163], v[132:133]
    v_pk_fma_f32 v[134:135], v[164:165], v[166:167], v[134:135]
    v_pk_fma_f32 v[136:137], v[104:105], v[26:27], v[54:55] op_sel_hi:[0,1,1]
    v_pk_fma_f32 v[140:141], v[106:107], v[26:27], v[54:55] op_sel_hi:[0,1,1]
    v_pk_fma_f32 v[144:145], v[108:109], v[26:27], v[54:55] op_sel_hi:[0,1,1]
    v_pk_fma_f32 v[148:149], v[110:111], v[26:27], v[54:55] op_sel_hi:[0,1,1]
    v_pk_fma_f32 v[152:153], v[112:113], v[26:27], v[54:55] op_sel_hi:[0,1,1]
    v_pk_fma_f32 v[156:157], v[114:115], v[26:27], v[54:55] op_sel_hi:[0,1,1]
    v_pk_fma_f32 v[160:161], v[116:117], v[26:27], v[54:55] op_sel_hi:[0,1,1]
    v_pk_fma_f32 v[164:165], v[118:119], v[26:27], v[54:55] op_sel_hi:[0,1,1]
    v_pk_mul_f32 v[138:139], v[136:137], v[136:137]
    v_pk_mul_f32 v[142:143], v[140:141], v[140:141]
    v_pk_mul_f32 v[146:147], v[144:145], v[144:145]
    v_pk_mul_f32 v[150:151], v[148:149], v[148:149]
    v_pk_mul_f32 v[154:155], v[152:153], v[152:153]
    v_pk_mul_f32 v[158:159], v[156:157], v[156:157]
    v_pk_mul_f32 v[162:163], v[160:161], v[160:161]
    v_pk_mul_f32 v[166:167], v[164:165], v[164:165]
    v_pk_fma_f32 v[138:139], v[138:139], v[100:101], v[102:103]
    v_pk_fma_f32 v[142:143], v[142:143], v[100:101], v[102:103]
    v_pk_fma_f32 v[146:147], v[146:147], v[100:101], v[102:103]
    v_pk_fma_f32 v[150:151], v[150:151], v[100:101], v[102:103]
    v_pk_fma_f32 v[154:155], v[154:155], v[100:101], v[102:103]
    v_pk_fma_f32 v[158:159], v[158:159], v[100:101], v[102:103]
    v_pk_fma_f32 v[162:163], v[162:163], v[100:101], v[102:103]
    v_pk_fma_f32 v[166:167], v[166:167], v[100:101], v[102:103]
    v_pk_mul_f32 v[138:139], v[138:139], v[136:137]
    v_pk_mul_f32 v[142:143], v[142:143], v[140:141]
    v_pk_mul_f32 v[146:147], v[146:147], v[144:145]
    v_pk_mul_f32 v[150:151], v[150:151], v[148:149]
    v_pk_mul_f32 v[154:155], v[154:155], v[152:153]
    v_pk_mul_f32 v[158:159], v[158:159], v[156:157]
    v_pk_mul_f32 v[162:163], v[162:163], v[160:161]
    v_pk_mul_f32 v[166:167], v[166:167], v[164:165]
    v_exp_f32 v138, v138
    v_exp_f32 v139, v139
    v_exp_f32 v142, v142
    v_exp_f32 v143, v143
    v_exp_f32 v146, v146
    v_exp_f32 v147, v147
    v_exp_f32 v150, v150
    v_exp_f32 v151, v151
    v_exp_f32 v154, v154
    v_exp_f32 v155, v155
    v_exp_f32 v158, v158
    v_exp_f32 v159, v159
    v_exp_f32 v162, v162
    v_exp_f32 v163, v163
    v_exp_f32 v166, v166
    v_exp_f32 v167, v167
    v_pk_mul_f32 v[136:137], v[136:137], v[82:83]
    v_pk_mul_f32 v[140:141], v[140:141], v[82:83]
    v_pk_mul_f32 v[144:145], v[144:145], v[82:83]
    v_pk_mul_f32 v[148:149], v[148:149], v[82:83]
    v_pk_mul_f32 v[152:153], v[152:153], v[82:83]
    v_pk_mul_f32 v[156:157], v[156:157], v[82:83]
    v_pk_mul_f32 v[160:161], v[160:161], v[82:83]
    v_pk_mul_f32 v[164:165], v[164:165], v[82:83]
    v_pk_add_f32 v[138:139], v[138:139], 1.0 op_sel_hi:[1,0]
    v_pk_add_f32 v[142:143], v[142:143], 1.0 op_sel_hi:[1,0]
    v_pk_add_f32 v[146:147], v[146:147], 1.0 op_sel_hi:[1,0]
    v_pk_add_f32 v[150:151], v[150:151], 1.0 op_sel_hi:[1,0]
    v_pk_add_f32 v[154:155], v[154:155], 1.0 op_sel_hi:[1,0]
    v_pk_add_f32 v[158:159], v[158:159], 1.0 op_sel_hi:[1,0]
    v_pk_add_f32 v[162:163], v[162:163], 1.0 op_sel_hi:[1,0]
    v_pk_add_f32 v[166:167], v[166:167], 1.0 op_sel_hi:[1,0]
    v_rcp_f32 v138, v138
    v_rcp_f32 v139, v139
    v_rcp_f32 v142, v142
    v_rcp_f32 v143, v143
    v_rcp_f32 v146, v146
    v_rcp_f32 v147, v147
    v_rcp_f32 v150, v150
    v_rcp_f32 v151, v151
    v_rcp_f32 v154, v154
    v_rcp_f32 v155, v155
    v_rcp_f32 v158, v158
    v_rcp_f32 v159, v159
    v_rcp_f32 v162, v162
    v_rcp_f32 v163, v163
    v_rcp_f32 v166, v166
    v_rcp_f32 v167, v167
    v_pk_fma_f32 v[120:121], v[136:137], v[138:139], v[120:121]
    v_pk_fma_f32 v[122:123], v[140:141], v[142:143], v[122:123]
    v_pk_fma_f32 v[124:125], v[144:145], v[146:147], v[124:125]
    v_pk_fma_f32 v[126:127], v[148:149], v[150:151], v[126:127]
    v_pk_fma_f32 v[128:129], v[152:153], v[154:155], v[128:129]
    v_pk_fma_f32 v[130:131], v[156:157], v[158:159], v[130:131]
    v_pk_fma_f32 v[132:133], v[160:161], v[162:163], v[132:133]
    v_pk_fma_f32 v[134:135], v[164:165], v[166:167], v[134:135]
    v_pk_fma_f32 v[136:137], v[104:105], v[28:29], v[56:57] op_sel_hi:[0,1,1]
    v_pk_fma_f32 v[140:141], v[106:107], v[28:29], v[56:57] op_sel_hi:[0,1,1]
    v_pk_fma_f32 v[144:145], v[108:109], v[28:29], v[56:57] op_sel_hi:[0,1,1]
    v_pk_fma_f32 v[148:149], v[110:111], v[28:29], v[56:57] op_sel_hi:[0,1,1]
    v_pk_fma_f32 v[152:153], v[112:113], v[28:29], v[56:57] op_sel_hi:[0,1,1]
    v_pk_fma_f32 v[156:157], v[114:115], v[28:29], v[56:57] op_sel_hi:[0,1,1]
    v_pk_fma_f32 v[160:161], v[116:117], v[28:29], v[56:57] op_sel_hi:[0,1,1]
    v_pk_fma_f32 v[164:165], v[118:119], v[28:29], v[56:57] op_sel_hi:[0,1,1]
    v_pk_mul_f32 v[138:139], v[136:137], v[136:137]
    v_pk_mul_f32 v[142:143], v[140:141], v[140:141]
    v_pk_mul_f32 v[146:147], v[144:145], v[144:145]
    v_pk_mul_f32 v[150:151], v[148:149], v[148:149]
    v_pk_mul_f32 v[154:155], v[152:153], v[152:153]
    v_pk_mul_f32 v[158:159], v[156:157], v[156:157]
    v_pk_mul_f32 v[162:163], v[160:161], v[160:161]
    v_pk_mul_f32 v[166:167], v[164:165], v[164:165]
    v_pk_fma_f32 v[138:139], v[138:139], v[100:101], v[102:103]
    v_pk_fma_f32 v[142:143], v[142:143], v[100:101], v[102:103]
    v_pk_fma_f32 v[146:147], v[146:147], v[100:101], v[102:103]
    v_pk_fma_f32 v[150:151], v[150:151], v[100:101], v[102:103]
    v_pk_fma_f32 v[154:155], v[154:155], v[100:101], v[102:103]
    v_pk_fma_f32 v[158:159], v[158:159], v[100:101], v[102:103]
    v_pk_fma_f32 v[162:163], v[162:163], v[100:101], v[102:103]
    v_pk_fma_f32 v[166:167], v[166:167], v[100:101], v[102:103]
    v_pk_mul_f32 v[138:139], v[138:139], v[136:137]
    v_pk_mul_f32 v[142:143], v[142:143], v[140:141]
    v_pk_mul_f32 v[146:147], v[146:147], v[144:145]
    v_pk_mul_f32 v[150:151], v[150:151], v[148:149]
    v_pk_mul_f32 v[154:155], v[154:155], v[152:153]
    v_pk_mul_f32 v[158:159], v[158:159], v[156:157]
    v_pk_mul_f32 v[162:163], v[162:163], v[160:161]
    v_pk_mul_f32 v[166:167], v[166:167], v[164:165]
    v_exp_f32 v138, v138
    v_exp_f32 v139, v139
    v_exp_f32 v142, v142
    v_exp_f32 v143, v143
    v_exp_f32 v146, v146
    v_exp_f32 v147, v147
    v_exp_f32 v150, v150
    v_exp_f32 v151, v151
    v_exp_f32 v154, v154
    v_exp_f32 v155, v155
    v_exp_f32 v158, v158
    v_exp_f32 v159, v159
    v_exp_f32 v162, v162
    v_exp_f32 v163, v163
    v_exp_f32 v166, v166
    v_exp_f32 v167, v167
    v_pk_mul_f32 v[136:137], v[136:137], v[84:85]
    v_pk_mul_f32 v[140:141], v[140:141], v[84:85]
    v_pk_mul_f32 v[144:145], v[144:145], v[84:85]
    v_pk_mul_f32 v[148:149], v[148:149], v[84:85]
    v_pk_mul_f32 v[152:153], v[152:153], v[84:85]
    v_pk_mul_f32 v[156:157], v[156:157], v[84:85]
    v_pk_mul_f32 v[160:161], v[160:161], v[84:85]
    v_pk_mul_f32 v[164:165], v[164:165], v[84:85]
    v_pk_add_f32 v[138:139], v[138:139], 1.0 op_sel_hi:[1,0]
    v_pk_add_f32 v[142:143], v[142:143], 1.0 op_sel_hi:[1,0]
    v_pk_add_f32 v[146:147], v[146:147], 1.0 op_sel_hi:[1,0]
    v_pk_add_f32 v[150:151], v[150:151], 1.0 op_sel_hi:[1,0]
    v_pk_add_f32 v[154:155], v[154:155], 1.0 op_sel_hi:[1,0]
    v_pk_add_f32 v[158:159], v[158:159], 1.0 op_sel_hi:[1,0]
    v_pk_add_f32 v[162:163], v[162:163], 1.0 op_sel_hi:[1,0]
    v_pk_add_f32 v[166:167], v[166:167], 1.0 op_sel_hi:[1,0]
    v_rcp_f32 v138, v138
    v_rcp_f32 v139, v139
    v_rcp_f32 v142, v142
    v_rcp_f32 v143, v143
    v_rcp_f32 v146, v146
    v_rcp_f32 v147, v147
    v_rcp_f32 v150, v150
    v_rcp_f32 v151, v151
    v_rcp_f32 v154, v154
    v_rcp_f32 v155, v155
    v_rcp_f32 v158, v158
    v_rcp_f32 v159, v159
    v_rcp_f32 v162, v162
    v_rcp_f32 v163, v163
    v_rcp_f32 v166, v166
    v_rcp_f32 v167, v167
    v_pk_fma_f32 v[120:121], v[136:137], v[138:139], v[120:121]
    v_pk_fma_f32 v[122:123], v[140:141], v[142:143], v[122:123]
    v_pk_fma_f32 v[124:125], v[144:145], v[146:147], v[124:125]
    v_pk_fma_f32 v[126:127], v[148:149], v[150:151], v[126:127]
    v_pk_fma_f32 v[128:129], v[152:153], v[154:155], v[128:129]
    v_pk_fma_f32 v[130:131], v[156:157], v[158:159], v[130:131]
    v_pk_fma_f32 v[132:133], v[160:161], v[162:163], v[132:133]
    v_pk_fma_f32 v[134:135], v[164:165], v[166:167], v[134:135]
    v_pk_fma_f32 v[136:137], v[104:105], v[30:31], v[58:59] op_sel_hi:[0,1,1]
    v_pk_fma_f32 v[140:141], v[106:107], v[30:31], v[58:59] op_sel_hi:[0,1,1]
    v_pk_fma_f32 v[144:145], v[108:109], v[30:31], v[58:59] op_sel_hi:[0,1,1]
    v_pk_fma_f32 v[148:149], v[110:111], v[30:31], v[58:59] op_sel_hi:[0,1,1]
    v_pk_fma_f32 v[152:153], v[112:113], v[30:31], v[58:59] op_sel_hi:[0,1,1]
    v_pk_fma_f32 v[156:157], v[114:115], v[30:31], v[58:59] op_sel_hi:[0,1,1]
    v_pk_fma_f32 v[160:161], v[116:117], v[30:31], v[58:59] op_sel_hi:[0,1,1]
    v_pk_fma_f32 v[164:165], v[118:119], v[30:31], v[58:59] op_sel_hi:[0,1,1]
    v_pk_mul_f32 v[138:139], v[136:137], v[136:137]
    v_pk_mul_f32 v[142:143], v[140:141], v[140:141]
    v_pk_mul_f32 v[146:147], v[144:145], v[144:145]
    v_pk_mul_f32 v[150:151], v[148:149], v[148:149]
    v_pk_mul_f32 v[154:155], v[152:153], v[152:153]
    v_pk_mul_f32 v[158:159], v[156:157], v[156:157]
    v_pk_mul_f32 v[162:163], v[160:161], v[160:161]
    v_pk_mul_f32 v[166:167], v[164:165], v[164:165]
    v_pk_fma_f32 v[138:139], v[138:139], v[100:101], v[102:103]
    v_pk_fma_f32 v[142:143], v[142:143], v[100:101], v[102:103]
    v_pk_fma_f32 v[146:147], v[146:147], v[100:101], v[102:103]
    v_pk_fma_f32 v[150:151], v[150:151], v[100:101], v[102:103]
    v_pk_fma_f32 v[154:155], v[154:155], v[100:101], v[102:103]
    v_pk_fma_f32 v[158:159], v[158:159], v[100:101], v[102:103]
    v_pk_fma_f32 v[162:163], v[162:163], v[100:101], v[102:103]
    v_pk_fma_f32 v[166:167], v[166:167], v[100:101], v[102:103]
    v_pk_mul_f32 v[138:139], v[138:139], v[136:137]
    v_pk_mul_f32 v[142:143], v[142:143], v[140:141]
    v_pk_mul_f32 v[146:147], v[146:147], v[144:145]
    v_pk_mul_f32 v[150:151], v[150:151], v[148:149]
    v_pk_mul_f32 v[154:155], v[154:155], v[152:153]
    v_pk_mul_f32 v[158:159], v[158:159], v[156:157]
    v_pk_mul_f32 v[162:163], v[162:163], v[160:161]
    v_pk_mul_f32 v[166:167], v[166:167], v[164:165]
    v_exp_f32 v138, v138
    v_exp_f32 v139, v139
    v_exp_f32 v142, v142
    v_exp_f32 v143, v143
    v_exp_f32 v146, v146
    v_exp_f32 v147, v147
    v_exp_f32 v150, v150
    v_exp_f32 v151, v151
    v_exp_f32 v154, v154
    v_exp_f32 v155, v155
    v_exp_f32 v158, v158
    v_exp_f32 v159, v159
    v_exp_f32 v162, v162
    v_exp_f32 v163, v163
    v_exp_f32 v166, v166
    v_exp_f32 v167, v167
    v_pk_mul_f32 v[136:137], v[136:137], v[86:87]
    v_pk_mul_f32 v[140:141], v[140:141], v[86:87]
    v_pk_mul_f32 v[144:145], v[144:145], v[86:87]
    v_pk_mul_f32 v[148:149], v[148:149], v[86:87]
    v_pk_mul_f32 v[152:153], v[152:153], v[86:87]
    v_pk_mul_f32 v[156:157], v[156:157], v[86:87]
    v_pk_mul_f32 v[160:161], v[160:161], v[86:87]
    v_pk_mul_f32 v[164:165], v[164:165], v[86:87]
    v_pk_add_f32 v[138:139], v[138:139], 1.0 op_sel_hi:[1,0]
    v_pk_add_f32 v[142:143], v[142:143], 1.0 op_sel_hi:[1,0]
    v_pk_add_f32 v[146:147], v[146:147], 1.0 op_sel_hi:[1,0]
    v_pk_add_f32 v[150:151], v[150:151], 1.0 op_sel_hi:[1,0]
    v_pk_add_f32 v[154:155], v[154:155], 1.0 op_sel_hi:[1,0]
    v_pk_add_f32 v[158:159], v[158:159], 1.0 op_sel_hi:[1,0]
    v_pk_add_f32 v[162:163], v[162:163], 1.0 op_sel_hi:[1,0]
    v_pk_add_f32 v[166:167], v[166:167], 1.0 op_sel_hi:[1,0]
    v_rcp_f32 v138, v138
    v_rcp_f32 v139, v139
    v_rcp_f32 v142, v142
    v_rcp_f32 v143, v143
    v_rcp_f32 v146, v146
    v_rcp_f32 v147, v147
    v_rcp_f32 v150, v150
    v_rcp_f32 v151, v151
    v_rcp_f32 v154, v154
    v_rcp_f32 v155, v155
    v_rcp_f32 v158, v158
    v_rcp_f32 v159, v159
    v_rcp_f32 v162, v162
    v_rcp_f32 v163, v163
    v_rcp_f32 v166, v166
    v_rcp_f32 v167, v167
    v_pk_fma_f32 v[120:121], v[136:137], v[138:139], v[120:121]
    v_pk_fma_f32 v[122:123], v[140:141], v[142:143], v[122:123]
    v_pk_fma_f32 v[124:125], v[144:145], v[146:147], v[124:125]
    v_pk_fma_f32 v[126:127], v[148:149], v[150:151], v[126:127]
    v_pk_fma_f32 v[128:129], v[152:153], v[154:155], v[128:129]
    v_pk_fma_f32 v[130:131], v[156:157], v[158:159], v[130:131]
    v_pk_fma_f32 v[132:133], v[160:161], v[162:163], v[132:133]
    v_pk_fma_f32 v[134:135], v[164:165], v[166:167], v[134:135]
    v_pk_fma_f32 v[136:137], v[104:105], v[32:33], v[60:61] op_sel_hi:[0,1,1]
    v_pk_fma_f32 v[140:141], v[106:107], v[32:33], v[60:61] op_sel_hi:[0,1,1]
    v_pk_fma_f32 v[144:145], v[108:109], v[32:33], v[60:61] op_sel_hi:[0,1,1]
    v_pk_fma_f32 v[148:149], v[110:111], v[32:33], v[60:61] op_sel_hi:[0,1,1]
    v_pk_fma_f32 v[152:153], v[112:113], v[32:33], v[60:61] op_sel_hi:[0,1,1]
    v_pk_fma_f32 v[156:157], v[114:115], v[32:33], v[60:61] op_sel_hi:[0,1,1]
    v_pk_fma_f32 v[160:161], v[116:117], v[32:33], v[60:61] op_sel_hi:[0,1,1]
    v_pk_fma_f32 v[164:165], v[118:119], v[32:33], v[60:61] op_sel_hi:[0,1,1]
    v_pk_mul_f32 v[138:139], v[136:137], v[136:137]
    v_pk_mul_f32 v[142:143], v[140:141], v[140:141]
    v_pk_mul_f32 v[146:147], v[144:145], v[144:145]
    v_pk_mul_f32 v[150:151], v[148:149], v[148:149]
    v_pk_mul_f32 v[154:155], v[152:153], v[152:153]
    v_pk_mul_f32 v[158:159], v[156:157], v[156:157]
    v_pk_mul_f32 v[162:163], v[160:161], v[160:161]
    v_pk_mul_f32 v[166:167], v[164:165], v[164:165]
    v_pk_fma_f32 v[138:139], v[138:139], v[100:101], v[102:103]
    v_pk_fma_f32 v[142:143], v[142:143], v[100:101], v[102:103]
    v_pk_fma_f32 v[146:147], v[146:147], v[100:101], v[102:103]
    v_pk_fma_f32 v[150:151], v[150:151], v[100:101], v[102:103]
    v_pk_fma_f32 v[154:155], v[154:155], v[100:101], v[102:103]
    v_pk_fma_f32 v[158:159], v[158:159], v[100:101], v[102:103]
    v_pk_fma_f32 v[162:163], v[162:163], v[100:101], v[102:103]
    v_pk_fma_f32 v[166:167], v[166:167], v[100:101], v[102:103]
    v_pk_mul_f32 v[138:139], v[138:139], v[136:137]
    v_pk_mul_f32 v[142:143], v[142:143], v[140:141]
    v_pk_mul_f32 v[146:147], v[146:147], v[144:145]
    v_pk_mul_f32 v[150:151], v[150:151], v[148:149]
    v_pk_mul_f32 v[154:155], v[154:155], v[152:153]
    v_pk_mul_f32 v[158:159], v[158:159], v[156:157]
    v_pk_mul_f32 v[162:163], v[162:163], v[160:161]
    v_pk_mul_f32 v[166:167], v[166:167], v[164:165]
    v_exp_f32 v138, v138
    v_exp_f32 v139, v139
    v_exp_f32 v142, v142
    v_exp_f32 v143, v143
    v_exp_f32 v146, v146
    v_exp_f32 v147, v147
    v_exp_f32 v150, v150
    v_exp_f32 v151, v151
    v_exp_f32 v154, v154
    v_exp_f32 v155, v155
    v_exp_f32 v158, v158
    v_exp_f32 v159, v159
    v_exp_f32 v162, v162
    v_exp_f32 v163, v163
    v_exp_f32 v166, v166
    v_exp_f32 v167, v167
    v_pk_mul_f32 v[136:137], v[136:137], v[88:89]
    v_pk_mul_f32 v[140:141], v[140:141], v[88:89]
    v_pk_mul_f32 v[144:145], v[144:145], v[88:89]
    v_pk_mul_f32 v[148:149], v[148:149], v[88:89]
    v_pk_mul_f32 v[152:153], v[152:153], v[88:89]
    v_pk_mul_f32 v[156:157], v[156:157], v[88:89]
    v_pk_mul_f32 v[160:161], v[160:161], v[88:89]
    v_pk_mul_f32 v[164:165], v[164:165], v[88:89]
    v_pk_add_f32 v[138:139], v[138:139], 1.0 op_sel_hi:[1,0]
    v_pk_add_f32 v[142:143], v[142:143], 1.0 op_sel_hi:[1,0]
    v_pk_add_f32 v[146:147], v[146:147], 1.0 op_sel_hi:[1,0]
    v_pk_add_f32 v[150:151], v[150:151], 1.0 op_sel_hi:[1,0]
    v_pk_add_f32 v[154:155], v[154:155], 1.0 op_sel_hi:[1,0]
    v_pk_add_f32 v[158:159], v[158:159], 1.0 op_sel_hi:[1,0]
    v_pk_add_f32 v[162:163], v[162:163], 1.0 op_sel_hi:[1,0]
    v_pk_add_f32 v[166:167], v[166:167], 1.0 op_sel_hi:[1,0]
    v_rcp_f32 v138, v138
    v_rcp_f32 v139, v139
    v_rcp_f32 v142, v142
    v_rcp_f32 v143, v143
    v_rcp_f32 v146, v146
    v_rcp_f32 v147, v147
    v_rcp_f32 v150, v150
    v_rcp_f32 v151, v151
    v_rcp_f32 v154, v154
    v_rcp_f32 v155, v155
    v_rcp_f32 v158, v158
    v_rcp_f32 v159, v159
    v_rcp_f32 v162, v162
    v_rcp_f32 v163, v163
    v_rcp_f32 v166, v166
    v_rcp_f32 v167, v167
    v_pk_fma_f32 v[120:121], v[136:137], v[138:139], v[120:121]
    v_pk_fma_f32 v[122:123], v[140:141], v[142:143], v[122:123]
    v_pk_fma_f32 v[124:125], v[144:145], v[146:147], v[124:125]
    v_pk_fma_f32 v[126:127], v[148:149], v[150:151], v[126:127]
    v_pk_fma_f32 v[128:129], v[152:153], v[154:155], v[128:129]
    v_pk_fma_f32 v[130:131], v[156:157], v[158:159], v[130:131]
    v_pk_fma_f32 v[132:133], v[160:161], v[162:163], v[132:133]
    v_pk_fma_f32 v[134:135], v[164:165], v[166:167], v[134:135]
    v_pk_fma_f32 v[136:137], v[104:105], v[34:35], v[62:63] op_sel_hi:[0,1,1]
    v_pk_fma_f32 v[140:141], v[106:107], v[34:35], v[62:63] op_sel_hi:[0,1,1]
    v_pk_fma_f32 v[144:145], v[108:109], v[34:35], v[62:63] op_sel_hi:[0,1,1]
    v_pk_fma_f32 v[148:149], v[110:111], v[34:35], v[62:63] op_sel_hi:[0,1,1]
    v_pk_fma_f32 v[152:153], v[112:113], v[34:35], v[62:63] op_sel_hi:[0,1,1]
    v_pk_fma_f32 v[156:157], v[114:115], v[34:35], v[62:63] op_sel_hi:[0,1,1]
    v_pk_fma_f32 v[160:161], v[116:117], v[34:35], v[62:63] op_sel_hi:[0,1,1]
    v_pk_fma_f32 v[164:165], v[118:119], v[34:35], v[62:63] op_sel_hi:[0,1,1]
    v_pk_mul_f32 v[138:139], v[136:137], v[136:137]
    v_pk_mul_f32 v[142:143], v[140:141], v[140:141]
    v_pk_mul_f32 v[146:147], v[144:145], v[144:145]
    v_pk_mul_f32 v[150:151], v[148:149], v[148:149]
    v_pk_mul_f32 v[154:155], v[152:153], v[152:153]
    v_pk_mul_f32 v[158:159], v[156:157], v[156:157]
    v_pk_mul_f32 v[162:163], v[160:161], v[160:161]
    v_pk_mul_f32 v[166:167], v[164:165], v[164:165]
    v_pk_fma_f32 v[138:139], v[138:139], v[100:101], v[102:103]
    v_pk_fma_f32 v[142:143], v[142:143], v[100:101], v[102:103]
    v_pk_fma_f32 v[146:147], v[146:147], v[100:101], v[102:103]
    v_pk_fma_f32 v[150:151], v[150:151], v[100:101], v[102:103]
    v_pk_fma_f32 v[154:155], v[154:155], v[100:101], v[102:103]
    v_pk_fma_f32 v[158:159], v[158:159], v[100:101], v[102:103]
    v_pk_fma_f32 v[162:163], v[162:163], v[100:101], v[102:103]
    v_pk_fma_f32 v[166:167], v[166:167], v[100:101], v[102:103]
    v_pk_mul_f32 v[138:139], v[138:139], v[136:137]
    v_pk_mul_f32 v[142:143], v[142:143], v[140:141]
    v_pk_mul_f32 v[146:147], v[146:147], v[144:145]
    v_pk_mul_f32 v[150:151], v[150:151], v[148:149]
    v_pk_mul_f32 v[154:155], v[154:155], v[152:153]
    v_pk_mul_f32 v[158:159], v[158:159], v[156:157]
    v_pk_mul_f32 v[162:163], v[162:163], v[160:161]
    v_pk_mul_f32 v[166:167], v[166:167], v[164:165]
    v_exp_f32 v138, v138
    v_exp_f32 v139, v139
    v_exp_f32 v142, v142
    v_exp_f32 v143, v143
    v_exp_f32 v146, v146
    v_exp_f32 v147, v147
    v_exp_f32 v150, v150
    v_exp_f32 v151, v151
    v_exp_f32 v154, v154
    v_exp_f32 v155, v155
    v_exp_f32 v158, v158
    v_exp_f32 v159, v159
    v_exp_f32 v162, v162
    v_exp_f32 v163, v163
    v_exp_f32 v166, v166
    v_exp_f32 v167, v167
    v_pk_mul_f32 v[136:137], v[136:137], v[90:91]
    v_pk_mul_f32 v[140:141], v[140:141], v[90:91]
    v_pk_mul_f32 v[144:145], v[144:145], v[90:91]
    v_pk_mul_f32 v[148:149], v[148:149], v[90:91]
    v_pk_mul_f32 v[152:153], v[152:153], v[90:91]
    v_pk_mul_f32 v[156:157], v[156:157], v[90:91]
    v_pk_mul_f32 v[160:161], v[160:161], v[90:91]
    v_pk_mul_f32 v[164:165], v[164:165], v[90:91]
    v_pk_add_f32 v[138:139], v[138:139], 1.0 op_sel_hi:[1,0]
    v_pk_add_f32 v[142:143], v[142:143], 1.0 op_sel_hi:[1,0]
    v_pk_add_f32 v[146:147], v[146:147], 1.0 op_sel_hi:[1,0]
    v_pk_add_f32 v[150:151], v[150:151], 1.0 op_sel_hi:[1,0]
    v_pk_add_f32 v[154:155], v[154:155], 1.0 op_sel_hi:[1,0]
    v_pk_add_f32 v[158:159], v[158:159], 1.0 op_sel_hi:[1,0]
    v_pk_add_f32 v[162:163], v[162:163], 1.0 op_sel_hi:[1,0]
    v_pk_add_f32 v[166:167], v[166:167], 1.0 op_sel_hi:[1,0]
    v_rcp_f32 v138, v138
    v_rcp_f32 v139, v139
    v_rcp_f32 v142, v142
    v_rcp_f32 v143, v143
    v_rcp_f32 v146, v146
    v_rcp_f32 v147, v147
    v_rcp_f32 v150, v150
    v_rcp_f32 v151, v151
    v_rcp_f32 v154, v154
    v_rcp_f32 v155, v155
    v_rcp_f32 v158, v158
    v_rcp_f32 v159, v159
    v_rcp_f32 v162, v162
    v_rcp_f32 v163, v163
    v_rcp_f32 v166, v166
    v_rcp_f32 v167, v167
    v_pk_fma_f32 v[120:121], v[136:137], v[138:139], v[120:121]
    v_pk_fma_f32 v[122:123], v[140:141], v[142:143], v[122:123]
    v_pk_fma_f32 v[124:125], v[144:145], v[146:147], v[124:125]
    v_pk_fma_f32 v[126:127], v[148:149], v[150:151], v[126:127]
    v_pk_fma_f32 v[128:129], v[152:153], v[154:155], v[128:129]
    v_pk_fma_f32 v[130:131], v[156:157], v[158:159], v[130:131]
    v_pk_fma_f32 v[132:133], v[160:161], v[162:163], v[132:133]
    v_pk_fma_f32 v[134:135], v[164:165], v[166:167], v[134:135]
    v_pk_fma_f32 v[136:137], v[104:105], v[36:37], v[64:65] op_sel_hi:[0,1,1]
    v_pk_fma_f32 v[140:141], v[106:107], v[36:37], v[64:65] op_sel_hi:[0,1,1]
    v_pk_fma_f32 v[144:145], v[108:109], v[36:37], v[64:65] op_sel_hi:[0,1,1]
    v_pk_fma_f32 v[148:149], v[110:111], v[36:37], v[64:65] op_sel_hi:[0,1,1]
    v_pk_fma_f32 v[152:153], v[112:113], v[36:37], v[64:65] op_sel_hi:[0,1,1]
    v_pk_fma_f32 v[156:157], v[114:115], v[36:37], v[64:65] op_sel_hi:[0,1,1]
    v_pk_fma_f32 v[160:161], v[116:117], v[36:37], v[64:65] op_sel_hi:[0,1,1]
    v_pk_fma_f32 v[164:165], v[118:119], v[36:37], v[64:65] op_sel_hi:[0,1,1]
    v_pk_mul_f32 v[138:139], v[136:137], v[136:137]
    v_pk_mul_f32 v[142:143], v[140:141], v[140:141]
    v_pk_mul_f32 v[146:147], v[144:145], v[144:145]
    v_pk_mul_f32 v[150:151], v[148:149], v[148:149]
    v_pk_mul_f32 v[154:155], v[152:153], v[152:153]
    v_pk_mul_f32 v[158:159], v[156:157], v[156:157]
    v_pk_mul_f32 v[162:163], v[160:161], v[160:161]
    v_pk_mul_f32 v[166:167], v[164:165], v[164:165]
    v_pk_fma_f32 v[138:139], v[138:139], v[100:101], v[102:103]
    v_pk_fma_f32 v[142:143], v[142:143], v[100:101], v[102:103]
    v_pk_fma_f32 v[146:147], v[146:147], v[100:101], v[102:103]
    v_pk_fma_f32 v[150:151], v[150:151], v[100:101], v[102:103]
    v_pk_fma_f32 v[154:155], v[154:155], v[100:101], v[102:103]
    v_pk_fma_f32 v[158:159], v[158:159], v[100:101], v[102:103]
    v_pk_fma_f32 v[162:163], v[162:163], v[100:101], v[102:103]
    v_pk_fma_f32 v[166:167], v[166:167], v[100:101], v[102:103]
    v_pk_mul_f32 v[138:139], v[138:139], v[136:137]
    v_pk_mul_f32 v[142:143], v[142:143], v[140:141]
    v_pk_mul_f32 v[146:147], v[146:147], v[144:145]
    v_pk_mul_f32 v[150:151], v[150:151], v[148:149]
    v_pk_mul_f32 v[154:155], v[154:155], v[152:153]
    v_pk_mul_f32 v[158:159], v[158:159], v[156:157]
    v_pk_mul_f32 v[162:163], v[162:163], v[160:161]
    v_pk_mul_f32 v[166:167], v[166:167], v[164:165]
    v_exp_f32 v138, v138
    v_exp_f32 v139, v139
    v_exp_f32 v142, v142
    v_exp_f32 v143, v143
    v_exp_f32 v146, v146
    v_exp_f32 v147, v147
    v_exp_f32 v150, v150
    v_exp_f32 v151, v151
    v_exp_f32 v154, v154
    v_exp_f32 v155, v155
    v_exp_f32 v158, v158
    v_exp_f32 v159, v159
    v_exp_f32 v162, v162
    v_exp_f32 v163, v163
    v_exp_f32 v166, v166
    v_exp_f32 v167, v167
    v_pk_mul_f32 v[136:137], v[136:137], v[92:93]
    v_pk_mul_f32 v[140:141], v[140:141], v[92:93]
    v_pk_mul_f32 v[144:145], v[144:145], v[92:93]
    v_pk_mul_f32 v[148:149], v[148:149], v[92:93]
    v_pk_mul_f32 v[152:153], v[152:153], v[92:93]
    v_pk_mul_f32 v[156:157], v[156:157], v[92:93]
    v_pk_mul_f32 v[160:161], v[160:161], v[92:93]
    v_pk_mul_f32 v[164:165], v[164:165], v[92:93]
    v_pk_add_f32 v[138:139], v[138:139], 1.0 op_sel_hi:[1,0]
    v_pk_add_f32 v[142:143], v[142:143], 1.0 op_sel_hi:[1,0]
    v_pk_add_f32 v[146:147], v[146:147], 1.0 op_sel_hi:[1,0]
    v_pk_add_f32 v[150:151], v[150:151], 1.0 op_sel_hi:[1,0]
    v_pk_add_f32 v[154:155], v[154:155], 1.0 op_sel_hi:[1,0]
    v_pk_add_f32 v[158:159], v[158:159], 1.0 op_sel_hi:[1,0]
    v_pk_add_f32 v[162:163], v[162:163], 1.0 op_sel_hi:[1,0]
    v_pk_add_f32 v[166:167], v[166:167], 1.0 op_sel_hi:[1,0]
    v_rcp_f32 v138, v138
    v_rcp_f32 v139, v139
    v_rcp_f32 v142, v142
    v_rcp_f32 v143, v143
    v_rcp_f32 v146, v146
    v_rcp_f32 v147, v147
    v_rcp_f32 v150, v150
    v_rcp_f32 v151, v151
    v_rcp_f32 v154, v154
    v_rcp_f32 v155, v155
    v_rcp_f32 v158, v158
    v_rcp_f32 v159, v159
    v_rcp_f32 v162, v162
    v_rcp_f32 v163, v163
    v_rcp_f32 v166, v166
    v_rcp_f32 v167, v167
    v_pk_fma_f32 v[120:121], v[136:137], v[138:139], v[120:121]
    v_pk_fma_f32 v[122:123], v[140:141], v[142:143], v[122:123]
    v_pk_fma_f32 v[124:125], v[144:145], v[146:147], v[124:125]
    v_pk_fma_f32 v[126:127], v[148:149], v[150:151], v[126:127]
    v_pk_fma_f32 v[128:129], v[152:153], v[154:155], v[128:129]
    v_pk_fma_f32 v[130:131], v[156:157], v[158:159], v[130:131]
    v_pk_fma_f32 v[132:133], v[160:161], v[162:163], v[132:133]
    v_pk_fma_f32 v[134:135], v[164:165], v[166:167], v[134:135]
    v_pk_fma_f32 v[136:137], v[104:105], v[38:39], v[66:67] op_sel_hi:[0,1,1]
    v_pk_fma_f32 v[140:141], v[106:107], v[38:39], v[66:67] op_sel_hi:[0,1,1]
    v_pk_fma_f32 v[144:145], v[108:109], v[38:39], v[66:67] op_sel_hi:[0,1,1]
    v_pk_fma_f32 v[148:149], v[110:111], v[38:39], v[66:67] op_sel_hi:[0,1,1]
    v_pk_fma_f32 v[152:153], v[112:113], v[38:39], v[66:67] op_sel_hi:[0,1,1]
    v_pk_fma_f32 v[156:157], v[114:115], v[38:39], v[66:67] op_sel_hi:[0,1,1]
    v_pk_fma_f32 v[160:161], v[116:117], v[38:39], v[66:67] op_sel_hi:[0,1,1]
    v_pk_fma_f32 v[164:165], v[118:119], v[38:39], v[66:67] op_sel_hi:[0,1,1]
    v_pk_mul_f32 v[138:139], v[136:137], v[136:137]
    v_pk_mul_f32 v[142:143], v[140:141], v[140:141]
    v_pk_mul_f32 v[146:147], v[144:145], v[144:145]
    v_pk_mul_f32 v[150:151], v[148:149], v[148:149]
    v_pk_mul_f32 v[154:155], v[152:153], v[152:153]
    v_pk_mul_f32 v[158:159], v[156:157], v[156:157]
    v_pk_mul_f32 v[162:163], v[160:161], v[160:161]
    v_pk_mul_f32 v[166:167], v[164:165], v[164:165]
    v_pk_fma_f32 v[138:139], v[138:139], v[100:101], v[102:103]
    v_pk_fma_f32 v[142:143], v[142:143], v[100:101], v[102:103]
    v_pk_fma_f32 v[146:147], v[146:147], v[100:101], v[102:103]
    v_pk_fma_f32 v[150:151], v[150:151], v[100:101], v[102:103]
    v_pk_fma_f32 v[154:155], v[154:155], v[100:101], v[102:103]
    v_pk_fma_f32 v[158:159], v[158:159], v[100:101], v[102:103]
    v_pk_fma_f32 v[162:163], v[162:163], v[100:101], v[102:103]
    v_pk_fma_f32 v[166:167], v[166:167], v[100:101], v[102:103]
    v_pk_mul_f32 v[138:139], v[138:139], v[136:137]
    v_pk_mul_f32 v[142:143], v[142:143], v[140:141]
    v_pk_mul_f32 v[146:147], v[146:147], v[144:145]
    v_pk_mul_f32 v[150:151], v[150:151], v[148:149]
    v_pk_mul_f32 v[154:155], v[154:155], v[152:153]
    v_pk_mul_f32 v[158:159], v[158:159], v[156:157]
    v_pk_mul_f32 v[162:163], v[162:163], v[160:161]
    v_pk_mul_f32 v[166:167], v[166:167], v[164:165]
    v_exp_f32 v138, v138
    v_exp_f32 v139, v139
    v_exp_f32 v142, v142
    v_exp_f32 v143, v143
    v_exp_f32 v146, v146
    v_exp_f32 v147, v147
    v_exp_f32 v150, v150
    v_exp_f32 v151, v151
    v_exp_f32 v154, v154
    v_exp_f32 v155, v155
    v_exp_f32 v158, v158
    v_exp_f32 v159, v159
    v_exp_f32 v162, v162
    v_exp_f32 v163, v163
    v_exp_f32 v166, v166
    v_exp_f32 v167, v167
    v_pk_mul_f32 v[136:137], v[136:137], v[94:95]
    v_pk_mul_f32 v[140:141], v[140:141], v[94:95]
    v_pk_mul_f32 v[144:145], v[144:145], v[94:95]
    v_pk_mul_f32 v[148:149], v[148:149], v[94:95]
    v_pk_mul_f32 v[152:153], v[152:153], v[94:95]
    v_pk_mul_f32 v[156:157], v[156:157], v[94:95]
    v_pk_mul_f32 v[160:161], v[160:161], v[94:95]
    v_pk_mul_f32 v[164:165], v[164:165], v[94:95]
    v_pk_add_f32 v[138:139], v[138:139], 1.0 op_sel_hi:[1,0]
    v_pk_add_f32 v[142:143], v[142:143], 1.0 op_sel_hi:[1,0]
    v_pk_add_f32 v[146:147], v[146:147], 1.0 op_sel_hi:[1,0]
    v_pk_add_f32 v[150:151], v[150:151], 1.0 op_sel_hi:[1,0]
    v_pk_add_f32 v[154:155], v[154:155], 1.0 op_sel_hi:[1,0]
    v_pk_add_f32 v[158:159], v[158:159], 1.0 op_sel_hi:[1,0]
    v_pk_add_f32 v[162:163], v[162:163], 1.0 op_sel_hi:[1,0]
    v_pk_add_f32 v[166:167], v[166:167], 1.0 op_sel_hi:[1,0]
    v_rcp_f32 v138, v138
    v_rcp_f32 v139, v139
    v_rcp_f32 v142, v142
    v_rcp_f32 v143, v143
    v_rcp_f32 v146, v146
    v_rcp_f32 v147, v147
    v_rcp_f32 v150, v150
    v_rcp_f32 v151, v151
    v_rcp_f32 v154, v154
    v_rcp_f32 v155, v155
    v_rcp_f32 v158, v158
    v_rcp_f32 v159, v159
    v_rcp_f32 v162, v162
    v_rcp_f32 v163, v163
    v_rcp_f32 v166, v166
    v_rcp_f32 v167, v167
    v_pk_fma_f32 v[120:121], v[136:137], v[138:139], v[120:121]
    v_pk_fma_f32 v[122:123], v[140:141], v[142:143], v[122:123]
    v_pk_fma_f32 v[124:125], v[144:145], v[146:147], v[124:125]
    v_pk_fma_f32 v[126:127], v[148:149], v[150:151], v[126:127]
    v_pk_fma_f32 v[128:129], v[152:153], v[154:155], v[128:129]
    v_pk_fma_f32 v[130:131], v[156:157], v[158:159], v[130:131]
    v_pk_fma_f32 v[132:133], v[160:161], v[162:163], v[132:133]
    v_pk_fma_f32 v[134:135], v[164:165], v[166:167], v[134:135]
    v_pk_fma_f32 v[136:137], v[104:105], v[40:41], v[68:69] op_sel_hi:[0,1,1]
    v_pk_fma_f32 v[140:141], v[106:107], v[40:41], v[68:69] op_sel_hi:[0,1,1]
    v_pk_fma_f32 v[144:145], v[108:109], v[40:41], v[68:69] op_sel_hi:[0,1,1]
    v_pk_fma_f32 v[148:149], v[110:111], v[40:41], v[68:69] op_sel_hi:[0,1,1]
    v_pk_fma_f32 v[152:153], v[112:113], v[40:41], v[68:69] op_sel_hi:[0,1,1]
    v_pk_fma_f32 v[156:157], v[114:115], v[40:41], v[68:69] op_sel_hi:[0,1,1]
    v_pk_fma_f32 v[160:161], v[116:117], v[40:41], v[68:69] op_sel_hi:[0,1,1]
    v_pk_fma_f32 v[164:165], v[118:119], v[40:41], v[68:69] op_sel_hi:[0,1,1]
    v_pk_mul_f32 v[138:139], v[136:137], v[136:137]
    v_pk_mul_f32 v[142:143], v[140:141], v[140:141]
    v_pk_mul_f32 v[146:147], v[144:145], v[144:145]
    v_pk_mul_f32 v[150:151], v[148:149], v[148:149]
    v_pk_mul_f32 v[154:155], v[152:153], v[152:153]
    v_pk_mul_f32 v[158:159], v[156:157], v[156:157]
    v_pk_mul_f32 v[162:163], v[160:161], v[160:161]
    v_pk_mul_f32 v[166:167], v[164:165], v[164:165]
    v_pk_fma_f32 v[138:139], v[138:139], v[100:101], v[102:103]
    v_pk_fma_f32 v[142:143], v[142:143], v[100:101], v[102:103]
    v_pk_fma_f32 v[146:147], v[146:147], v[100:101], v[102:103]
    v_pk_fma_f32 v[150:151], v[150:151], v[100:101], v[102:103]
    v_pk_fma_f32 v[154:155], v[154:155], v[100:101], v[102:103]
    v_pk_fma_f32 v[158:159], v[158:159], v[100:101], v[102:103]
    v_pk_fma_f32 v[162:163], v[162:163], v[100:101], v[102:103]
    v_pk_fma_f32 v[166:167], v[166:167], v[100:101], v[102:103]
    v_pk_mul_f32 v[138:139], v[138:139], v[136:137]
    v_pk_mul_f32 v[142:143], v[142:143], v[140:141]
    v_pk_mul_f32 v[146:147], v[146:147], v[144:145]
    v_pk_mul_f32 v[150:151], v[150:151], v[148:149]
    v_pk_mul_f32 v[154:155], v[154:155], v[152:153]
    v_pk_mul_f32 v[158:159], v[158:159], v[156:157]
    v_pk_mul_f32 v[162:163], v[162:163], v[160:161]
    v_pk_mul_f32 v[166:167], v[166:167], v[164:165]
    v_exp_f32 v138, v138
    v_exp_f32 v139, v139
    v_exp_f32 v142, v142
    v_exp_f32 v143, v143
    v_exp_f32 v146, v146
    v_exp_f32 v147, v147
    v_exp_f32 v150, v150
    v_exp_f32 v151, v151
    v_exp_f32 v154, v154
    v_exp_f32 v155, v155
    v_exp_f32 v158, v158
    v_exp_f32 v159, v159
    v_exp_f32 v162, v162
    v_exp_f32 v163, v163
    v_exp_f32 v166, v166
    v_exp_f32 v167, v167
    v_pk_mul_f32 v[136:137], v[136:137], v[96:97]
    v_pk_mul_f32 v[140:141], v[140:141], v[96:97]
    v_pk_mul_f32 v[144:145], v[144:145], v[96:97]
    v_pk_mul_f32 v[148:149], v[148:149], v[96:97]
    v_pk_mul_f32 v[152:153], v[152:153], v[96:97]
    v_pk_mul_f32 v[156:157], v[156:157], v[96:97]
    v_pk_mul_f32 v[160:161], v[160:161], v[96:97]
    v_pk_mul_f32 v[164:165], v[164:165], v[96:97]
    v_pk_add_f32 v[138:139], v[138:139], 1.0 op_sel_hi:[1,0]
    v_pk_add_f32 v[142:143], v[142:143], 1.0 op_sel_hi:[1,0]
    v_pk_add_f32 v[146:147], v[146:147], 1.0 op_sel_hi:[1,0]
    v_pk_add_f32 v[150:151], v[150:151], 1.0 op_sel_hi:[1,0]
    v_pk_add_f32 v[154:155], v[154:155], 1.0 op_sel_hi:[1,0]
    v_pk_add_f32 v[158:159], v[158:159], 1.0 op_sel_hi:[1,0]
    v_pk_add_f32 v[162:163], v[162:163], 1.0 op_sel_hi:[1,0]
    v_pk_add_f32 v[166:167], v[166:167], 1.0 op_sel_hi:[1,0]
    v_rcp_f32 v138, v138
    v_rcp_f32 v139, v139
    v_rcp_f32 v142, v142
    v_rcp_f32 v143, v143
    v_rcp_f32 v146, v146
    v_rcp_f32 v147, v147
    v_rcp_f32 v150, v150
    v_rcp_f32 v151, v151
    v_rcp_f32 v154, v154
    v_rcp_f32 v155, v155
    v_rcp_f32 v158, v158
    v_rcp_f32 v159, v159
    v_rcp_f32 v162, v162
    v_rcp_f32 v163, v163
    v_rcp_f32 v166, v166
    v_rcp_f32 v167, v167
    v_pk_fma_f32 v[120:121], v[136:137], v[138:139], v[120:121]
    v_pk_fma_f32 v[122:123], v[140:141], v[142:143], v[122:123]
    v_pk_fma_f32 v[124:125], v[144:145], v[146:147], v[124:125]
    v_pk_fma_f32 v[126:127], v[148:149], v[150:151], v[126:127]
    v_pk_fma_f32 v[128:129], v[152:153], v[154:155], v[128:129]
    v_pk_fma_f32 v[130:131], v[156:157], v[158:159], v[130:131]
    v_pk_fma_f32 v[132:133], v[160:161], v[162:163], v[132:133]
    v_pk_fma_f32 v[134:135], v[164:165], v[166:167], v[134:135]
    v_pk_fma_f32 v[136:137], v[104:105], v[42:43], v[70:71] op_sel_hi:[0,1,1]
    v_pk_fma_f32 v[140:141], v[106:107], v[42:43], v[70:71] op_sel_hi:[0,1,1]
    v_pk_fma_f32 v[144:145], v[108:109], v[42:43], v[70:71] op_sel_hi:[0,1,1]
    v_pk_fma_f32 v[148:149], v[110:111], v[42:43], v[70:71] op_sel_hi:[0,1,1]
    v_pk_fma_f32 v[152:153], v[112:113], v[42:43], v[70:71] op_sel_hi:[0,1,1]
    v_pk_fma_f32 v[156:157], v[114:115], v[42:43], v[70:71] op_sel_hi:[0,1,1]
    v_pk_fma_f32 v[160:161], v[116:117], v[42:43], v[70:71] op_sel_hi:[0,1,1]
    v_pk_fma_f32 v[164:165], v[118:119], v[42:43], v[70:71] op_sel_hi:[0,1,1]
    v_pk_mul_f32 v[138:139], v[136:137], v[136:137]
    v_pk_mul_f32 v[142:143], v[140:141], v[140:141]
    v_pk_mul_f32 v[146:147], v[144:145], v[144:145]
    v_pk_mul_f32 v[150:151], v[148:149], v[148:149]
    v_pk_mul_f32 v[154:155], v[152:153], v[152:153]
    v_pk_mul_f32 v[158:159], v[156:157], v[156:157]
    v_pk_mul_f32 v[162:163], v[160:161], v[160:161]
    v_pk_mul_f32 v[166:167], v[164:165], v[164:165]
    v_pk_fma_f32 v[138:139], v[138:139], v[100:101], v[102:103]
    v_pk_fma_f32 v[142:143], v[142:143], v[100:101], v[102:103]
    v_pk_fma_f32 v[146:147], v[146:147], v[100:101], v[102:103]
    v_pk_fma_f32 v[150:151], v[150:151], v[100:101], v[102:103]
    v_pk_fma_f32 v[154:155], v[154:155], v[100:101], v[102:103]
    v_pk_fma_f32 v[158:159], v[158:159], v[100:101], v[102:103]
    v_pk_fma_f32 v[162:163], v[162:163], v[100:101], v[102:103]
    v_pk_fma_f32 v[166:167], v[166:167], v[100:101], v[102:103]
    v_pk_mul_f32 v[138:139], v[138:139], v[136:137]
    v_pk_mul_f32 v[142:143], v[142:143], v[140:141]
    v_pk_mul_f32 v[146:147], v[146:147], v[144:145]
    v_pk_mul_f32 v[150:151], v[150:151], v[148:149]
    v_pk_mul_f32 v[154:155], v[154:155], v[152:153]
    v_pk_mul_f32 v[158:159], v[158:159], v[156:157]
    v_pk_mul_f32 v[162:163], v[162:163], v[160:161]
    v_pk_mul_f32 v[166:167], v[166:167], v[164:165]
    v_exp_f32 v138, v138
    v_exp_f32 v139, v139
    v_exp_f32 v142, v142
    v_exp_f32 v143, v143
    v_exp_f32 v146, v146
    v_exp_f32 v147, v147
    v_exp_f32 v150, v150
    v_exp_f32 v151, v151
    v_exp_f32 v154, v154
    v_exp_f32 v155, v155
    v_exp_f32 v158, v158
    v_exp_f32 v159, v159
    v_exp_f32 v162, v162
    v_exp_f32 v163, v163
    v_exp_f32 v166, v166
    v_exp_f32 v167, v167
    v_pk_mul_f32 v[136:137], v[136:137], v[98:99]
    v_pk_mul_f32 v[140:141], v[140:141], v[98:99]
    v_pk_mul_f32 v[144:145], v[144:145], v[98:99]
    v_pk_mul_f32 v[148:149], v[148:149], v[98:99]
    v_pk_mul_f32 v[152:153], v[152:153], v[98:99]
    v_pk_mul_f32 v[156:157], v[156:157], v[98:99]
    v_pk_mul_f32 v[160:161], v[160:161], v[98:99]
    v_pk_mul_f32 v[164:165], v[164:165], v[98:99]
    v_pk_add_f32 v[138:139], v[138:139], 1.0 op_sel_hi:[1,0]
    v_pk_add_f32 v[142:143], v[142:143], 1.0 op_sel_hi:[1,0]
    v_pk_add_f32 v[146:147], v[146:147], 1.0 op_sel_hi:[1,0]
    v_pk_add_f32 v[150:151], v[150:151], 1.0 op_sel_hi:[1,0]
    v_pk_add_f32 v[154:155], v[154:155], 1.0 op_sel_hi:[1,0]
    v_pk_add_f32 v[158:159], v[158:159], 1.0 op_sel_hi:[1,0]
    v_pk_add_f32 v[162:163], v[162:163], 1.0 op_sel_hi:[1,0]
    v_pk_add_f32 v[166:167], v[166:167], 1.0 op_sel_hi:[1,0]
    v_rcp_f32 v138, v138
    v_rcp_f32 v139, v139
    v_rcp_f32 v142, v142
    v_rcp_f32 v143, v143
    v_rcp_f32 v146, v146
    v_rcp_f32 v147, v147
    v_rcp_f32 v150, v150
    v_rcp_f32 v151, v151
    v_rcp_f32 v154, v154
    v_rcp_f32 v155, v155
    v_rcp_f32 v158, v158
    v_rcp_f32 v159, v159
    v_rcp_f32 v162, v162
    v_rcp_f32 v163, v163
    v_rcp_f32 v166, v166
    v_rcp_f32 v167, v167
    v_pk_fma_f32 v[120:121], v[136:137], v[138:139], v[120:121]
    v_pk_fma_f32 v[122:123], v[140:141], v[142:143], v[122:123]
    v_pk_fma_f32 v[124:125], v[144:145], v[146:147], v[124:125]
    v_pk_fma_f32 v[126:127], v[148:149], v[150:151], v[126:127]
    v_pk_fma_f32 v[128:129], v[152:153], v[154:155], v[128:129]
    v_pk_fma_f32 v[130:131], v[156:157], v[158:159], v[130:131]
    v_pk_fma_f32 v[132:133], v[160:161], v[162:163], v[132:133]
    v_pk_fma_f32 v[134:135], v[164:165], v[166:167], v[134:135]
    v_add_f32 v120, v120, v121
    v_add_f32 v121, v122, v123
    v_add_f32 v122, v124, v125
    v_add_f32 v123, v126, v127
    v_add_f32 v124, v128, v129
    v_add_f32 v125, v130, v131
    v_add_f32 v126, v132, v133
    v_add_f32 v127, v134, v135
    s_nop 1
    v_add_f32_dpp v120, v120, v120 quad_perm:[1,0,3,2] row_mask:0xf bank_mask:0xf
    v_add_f32_dpp v121, v121, v121 quad_perm:[1,0,3,2] row_mask:0xf bank_mask:0xf
    v_add_f32_dpp v122, v122, v122 quad_perm:[1,0,3,2] row_mask:0xf bank_mask:0xf
    v_add_f32_dpp v123, v123, v123 quad_perm:[1,0,3,2] row_mask:0xf bank_mask:0xf
    v_add_f32_dpp v124, v124, v124 quad_perm:[1,0,3,2] row_mask:0xf bank_mask:0xf
    v_add_f32_dpp v125, v125, v125 quad_perm:[1,0,3,2] row_mask:0xf bank_mask:0xf
    v_add_f32_dpp v126, v126, v126 quad_perm:[1,0,3,2] row_mask:0xf bank_mask:0xf
    v_add_f32_dpp v127, v127, v127 quad_perm:[1,0,3,2] row_mask:0xf bank_mask:0xf
    v_add_f32_dpp v120, v120, v120 quad_perm:[2,3,0,1] row_mask:0xf bank_mask:0xf
    v_add_f32_dpp v121, v121, v121 quad_perm:[2,3,0,1] row_mask:0xf bank_mask:0xf
    v_add_f32_dpp v122, v122, v122 quad_perm:[2,3,0,1] row_mask:0xf bank_mask:0xf
    v_add_f32_dpp v123, v123, v123 quad_perm:[2,3,0,1] row_mask:0xf bank_mask:0xf
    v_add_f32_dpp v124, v124, v124 quad_perm:[2,3,0,1] row_mask:0xf bank_mask:0xf
    v_add_f32_dpp v125, v125, v125 quad_perm:[2,3,0,1] row_mask:0xf bank_mask:0xf
    v_add_f32_dpp v126, v126, v126 quad_perm:[2,3,0,1] row_mask:0xf bank_mask:0xf
    v_add_f32_dpp v127, v127, v127 quad_perm:[2,3,0,1] row_mask:0xf bank_mask:0xf
    v_add_f32_dpp v120, v120, v120 row_half_mirror row_mask:0xf bank_mask:0xf
    v_add_f32_dpp v121, v121, v121 row_half_mirror row_mask:0xf bank_mask:0xf
    v_add_f32_dpp v122, v122, v122 row_half_mirror row_mask:0xf bank_mask:0xf
    v_add_f32_dpp v123, v123, v123 row_half_mirror row_mask:0xf bank_mask:0xf
    v_add_f32_dpp v124, v124, v124 row_half_mirror row_mask:0xf bank_mask:0xf
    v_add_f32_dpp v125, v125, v125 row_half_mirror row_mask:0xf bank_mask:0xf
    v_add_f32_dpp v126, v126, v126 row_half_mirror row_mask:0xf bank_mask:0xf
    v_add_f32_dpp v127, v127, v127 row_half_mirror row_mask:0xf bank_mask:0xf
    v_add_f32_dpp v120, v120, v120 row_mirror row_mask:0xf bank_mask:0xf
    v_add_f32_dpp v121, v121, v121 row_mirror row_mask:0xf bank_mask:0xf
    v_add_f32_dpp v122, v122, v122 row_mirror row_mask:0xf bank_mask:0xf
    v_add_f32_dpp v123, v123, v123 row_mirror row_mask:0xf bank_mask:0xf
    v_add_f32_dpp v124, v124, v124 row_mirror row_mask:0xf bank_mask:0xf
    v_add_f32_dpp v125, v125, v125 row_mirror row_mask:0xf bank_mask:0xf
    v_add_f32_dpp v126, v126, v126 row_mirror row_mask:0xf bank_mask:0xf
    v_add_f32_dpp v127, v127, v127 row_mirror row_mask:0xf bank_mask:0xf
    v_mov_b32 v136, v120
    v_mov_b32 v137, v121
    v_mov_b32 v138, v122
    v_mov_b32 v139, v123
    v_mov_b32 v140, v124
    v_mov_b32 v141, v125
    v_mov_b32 v142, v126
    v_mov_b32 v143, v127
    v_permlane16_swap_b32 v120, v136
    v_permlane16_swap_b32 v121, v137
    v_permlane16_swap_b32 v122, v138
    v_permlane16_swap_b32 v123, v139
    v_permlane16_swap_b32 v124, v140
    v_permlane16_swap_b32 v125, v141
    v_permlane16_swap_b32 v126, v142
    v_permlane16_swap_b32 v127, v143
    v_add_f32 v120, v120, v136
    v_add_f32 v121, v121, v137
    v_add_f32 v122, v122, v138
    v_add_f32 v123, v123, v139
    v_add_f32 v124, v124, v140
    v_add_f32 v125, v125, v141
    v_add_f32 v126, v126, v142
    v_add_f32 v127, v127, v143
    v_mov_b32 v136, v120
    v_mov_b32 v137, v121
    v_mov_b32 v138, v122
    v_mov_b32 v139, v123
    v_mov_b32 v140, v124
    v_mov_b32 v141, v125
    v_mov_b32 v142, v126
    v_mov_b32 v143, v127
    v_permlane32_swap_b32 v120, v136
    v_permlane32_swap_b32 v121, v137
    v_permlane32_swap_b32 v122, v138
    v_permlane32_swap_b32 v123, v139
    v_permlane32_swap_b32 v124, v140
    v_permlane32_swap_b32 v125, v141
    v_permlane32_swap_b32 v126, v142
    v_permlane32_swap_b32 v127, v143
    v_add_f32 v120, v120, v136
    v_add_f32 v121, v121, v137
    v_add_f32 v122, v122, v138
    v_add_f32 v123, v123, v139
    v_add_f32 v124, v124, v140
    v_add_f32 v125, v125, v141
    v_add_f32 v126, v126, v142
    v_add_f32 v127, v127, v143
    v_cvt_pk_bf16_f32 v136, v120, v121
    v_cvt_pk_bf16_f32 v137, v122, v123
    v_cvt_pk_bf16_f32 v138, v124, v125
    v_cvt_pk_bf16_f32 v139, v126, v127
    v_lshlrev_b32 v120, 16, v136
    v_and_b32 v121, 0xffff0000, v136
    v_lshlrev_b32 v122, 16, v137
    v_and_b32 v123, 0xffff0000, v137
    v_lshlrev_b32 v124, 16, v138
    v_and_b32 v125, 0xffff0000, v138
    v_lshlrev_b32 v126, 16, v139
    v_and_b32 v127, 0xffff0000, v139
    v_add_f32 v120, v120, v13
    v_add_f32 v121, v121, v13
    v_add_f32 v122, v122, v13
    v_add_f32 v123, v123, v13
    v_add_f32 v124, v124, v13
    v_add_f32 v125, v125, v13
    v_add_f32 v126, v126, v13
    v_add_f32 v127, v127, v13
    v_cvt_pk_bf16_f32 v136, v120, v121
    v_cvt_pk_bf16_f32 v137, v122, v123
    v_cvt_pk_bf16_f32 v138, v124, v125
    v_cvt_pk_bf16_f32 v139, v126, v127
    v_mov_b32 v145, s61
    v_lshlrev_b32 v2, 3, v1
    v_mov_b32 v144, v136
    v_cmp_eq_u32 vcc, 1, v1
    s_nop 1
    v_cndmask_b32 v144, v144, v137, vcc
    v_cmp_eq_u32 vcc, 2, v1
    s_nop 1
    v_cndmask_b32 v144, v144, v138, vcc
    v_cmp_eq_u32 vcc, 3, v1
    s_nop 1
    v_cndmask_b32 v144, v144, v139, vcc
    s_mul_i32 s52, s35, 96
    s_mul_i32 s53, s30, 32
    s_add_u32 s52, s52, s53
    s_add_u32 s54, s52, 16384
    s_mov_b64 exec, 15
    buffer_store_dwordx2 v[144:145], v2, s[48:51], s54 offen sc1
    s_mov_b64 exec, -1
    s_cmp_eq_u32 s33, 7
    s_cbranch_scc1 L_pf_done
    s_and_b32 s52, s32, 1
    s_lshl1_add_u32 s52, s31, s52
    s_mul_i32 s52, s52, 229376
    s_lshl_b32 s53, s33, 7
    s_add_u32 s52, s52, s53
    s_cmp_eq_u32 s30, 1
    s_cbranch_scc1 L_pf1
    s_cmp_eq_u32 s30, 2
    s_cbranch_scc1 L_pf2
    s_mov_b32 m0, 55296
    s_add_u32 s53, s52, 0
    buffer_load_dwordx4 v10, s[36:39], s53 offen nt lds
    s_mov_b32 m0, 58368
    s_add_u32 s53, s52, 21504
    buffer_load_dwordx4 v11, s[36:39], s53 offen nt lds
    s_mov_b32 m0, 61440
    s_add_u32 s53, s52, 43008
    buffer_load_dwordx4 v10, s[36:39], s53 offen nt lds
    s_mov_b32 m0, 64512
    s_add_u32 s53, s52, 64512
    buffer_load_dwordx4 v11, s[36:39], s53 offen nt lds
    s_setprio 0
    s_mov_b32 m0, 67584
    s_add_u32 s53, s52, 86016
    buffer_load_dwordx4 v10, s[36:39], s53 offen nt lds
    s_mov_b32 m0, 70656
    s_add_u32 s53, s52, 107520
    buffer_load_dwordx4 v11, s[36:39], s53 offen nt lds
    s_mov_b32 m0, 73728
    s_add_u32 s53, s52, 129024
    buffer_load_dwordx4 v10, s[36:39], s53 offen nt lds
    s_mov_b32 m0, 76800
    s_add_u32 s53, s52, 150528
    buffer_load_dwordx4 v11, s[36:39], s53 offen nt lds
    s_mov_b32 m0, 79872
    s_add_u32 s53, s52, 172032
    buffer_load_dwordx4 v10, s[36:39], s53 offen nt lds
    s_mov_b32 m0, 82944
    s_add_u32 s53, s52, 193536
    buffer_load_dwordx4 v11, s[36:39], s53 offen nt lds
    s_mov_b32 m0, 86016
    s_add_u32 s53, s52, 215040
    buffer_load_dwordx4 v10, s[36:39], s53 offen nt lds
    s_branch L_pf_done
L_pf1:
    s_mov_b32 m0, 56320
    s_add_u32 s53, s52, 7168
    buffer_load_dwordx4 v11, s[36:39], s53 offen nt lds
    s_mov_b32 m0, 59392
    s_add_u32 s53, s52, 28672
    buffer_load_dwordx4 v10, s[36:39], s53 offen nt lds
    s_mov_b32 m0, 62464
    s_add_u32 s53, s52, 50176
    buffer_load_dwordx4 v11, s[36:39], s53 offen nt lds
    s_mov_b32 m0, 65536
    s_add_u32 s53, s52, 71680
    buffer_load_dwordx4 v10, s[36:39], s53 offen nt lds
    s_setprio 0
    s_mov_b32 m0, 68608
    s_add_u32 s53, s52, 93184
    buffer_load_dwordx4 v11, s[36:39], s53 offen nt lds
    s_mov_b32 m0, 71680
    s_add_u32 s53, s52, 114688
    buffer_load_dwordx4 v10, s[36:39], s53 offen nt lds
    s_mov_b32 m0, 74752
    s_add_u32 s53, s52, 136192
    buffer_load_dwordx4 v11, s[36:39], s53 offen nt lds
    s_mov_b32 m0, 77824
    s_add_u32 s53, s52, 157696
    buffer_load_dwordx4 v10, s[36:39], s53 offen nt lds
    s_mov_b32 m0, 80896
    s_add_u32 s53, s52, 179200
    buffer_load_dwordx4 v11, s[36:39], s53 offen nt lds
    s_mov_b32 m0, 83968
    s_add_u32 s53, s52, 200704
    buffer_load_dwordx4 v10, s[36:39], s53 offen nt lds
    s_mov_b32 m0, 87040
    s_add_u32 s53, s52, 222208
    buffer_load_dwordx4 v11, s[36:39], s53 offen nt lds
    s_branch L_pf_done
L_pf2:
    s_mov_b32 m0, 57344
    s_add_u32 s53, s52, 14336
    buffer_load_dwordx4 v10, s[36:39], s53 offen nt lds
    s_mov_b32 m0, 60416
    s_add_u32 s53, s52, 35840
    buffer_load_dwordx4 v11, s[36:39], s53 offen nt lds
    s_mov_b32 m0, 63488
    s_add_u32 s53, s52, 57344
    buffer_load_dwordx4 v10, s[36:39], s53 offen nt lds
    s_mov_b32 m0, 66560
    s_add_u32 s53, s52, 78848
    buffer_load_dwordx4 v11, s[36:39], s53 offen nt lds
    s_setprio 0
    s_mov_b32 m0, 69632
    s_add_u32 s53, s52, 100352
    buffer_load_dwordx4 v10, s[36:39], s53 offen nt lds
    s_mov_b32 m0, 72704
    s_add_u32 s53, s52, 121856
    buffer_load_dwordx4 v11, s[36:39], s53 offen nt lds
    s_mov_b32 m0, 75776
    s_add_u32 s53, s52, 143360
    buffer_load_dwordx4 v10, s[36:39], s53 offen nt lds
    s_mov_b32 m0, 78848
    s_add_u32 s53, s52, 164864
    buffer_load_dwordx4 v11, s[36:39], s53 offen nt lds
    s_mov_b32 m0, 81920
    s_add_u32 s53, s52, 186368
    buffer_load_dwordx4 v10, s[36:39], s53 offen nt lds
    s_mov_b32 m0, 84992
    s_add_u32 s53, s52, 207872
    buffer_load_dwordx4 v11, s[36:39], s53 offen nt lds
L_pf_done:
    s_waitcnt lgkmcnt(0)
    s_barrier
    s_setprio 3
    v_mov_b32 v12, 1
    s_waitcnt vmcnt(0)
    s_mov_b64 exec, 1
    ds_add_u32 v15, v12 offset:16
    s_waitcnt lgkmcnt(0)
    s_endpgm
L_qmain:
    s_load_dword s46, s[28:29], 327680
    s_getreg_b32 s45, hwreg(HW_REG_XCC_ID, 0, 3)
    s_and_b32 s31, s2, 7
    s_lshr_b32 s33, s2, 3
    s_lshr_b32 s32, s2, 6
    s_add_u32 s33, s33, s32
    s_and_b32 s33, s33, 7
    s_lshl3_add_u32 s34, s32, s31
    s_lshl3_add_u32 s35, s34, s33
    s_mov_b32 s48, s28
    s_mov_b32 s49, s29
    s_mov_b32 s50, 536870912
    s_mov_b32 s51, 0x20000
    v_lshrrev_b32 v3, 4, v1
    v_and_b32 v5, 15, v1
    v_and_b32 v8, 3, v1
    v_lshlrev_b32 v4, 2, v5
    v_mov_b32 v17, -1
    v_mov_b32 v16, -1
    v_and_b32 v4, 31, v1
    v_lshlrev_b32 v4, 3, v4
    ds_write_b64 v4, v[16:17] offset:7808
    v_mul_u32_u24 v4, 896, v3
    v_mul_u32_u24 v6, 56, v5
    v_add_u32 v6, v4, v6
    v_lshlrev_b32 v10, 4, v5
    v_lshl_add_u32 v10, v3, 11, v10
    s_and_b32 s54, s32, 1
    s_lshl1_add_u32 s54, s33, s54
    s_lshr_b32 s47, s32, 1
    s_lshl4_add_u32 s44, s31, s54
    s_lshl1_add_u32 s44, s44, s47
    s_lshl_b32 s44, s44, 10
    s_add_u32 s44, s44, 65536
    s_lshl2_add_u32 s56, s31, s32
    s_lshl3_add_u32 s56, s56, s33
    s_lshl_b32 s56, s56, 5
    s_add_u32 s56, s56, 8192
    s_waitcnt vmcnt(0)
    ds_read_b64 v[16:17], v6 offset:34816
    ds_read_b64 v[18:19], v6 offset:34824
    ds_read_b64 v[20:21], v6 offset:34832
    ds_read_b64 v[22:23], v6 offset:34840
    ds_read_b64 v[24:25], v6 offset:34848
    ds_read_b64 v[26:27], v6 offset:34856
    ds_read_b64 v[28:29], v6 offset:34864
    v_mov_b32 v62, 0
    v_mov_b32 v63, 0
    v_mov_b32 v64, 0
    v_mov_b32 v65, 0
    s_waitcnt lgkmcnt(0)
    v_lshlrev_b32 v32, 16, v16
    v_and_b32 v33, 0xffff0000, v16
    v_lshlrev_b32 v34, 16, v17
    v_and_b32 v35, 0xffff0000, v17
    v_lshlrev_b32 v36, 16, v18
    v_and_b32 v37, 0xffff0000, v18
    v_lshlrev_b32 v38, 16, v19
    v_and_b32 v39, 0xffff0000, v19
    v_lshlrev_b32 v40, 16, v20
    v_and_b32 v41, 0xffff0000, v20
    v_lshlrev_b32 v42, 16, v21
    v_and_b32 v43, 0xffff0000, v21
    v_lshlrev_b32 v44, 16, v22
    v_and_b32 v45, 0xffff0000, v22
    v_lshlrev_b32 v46, 16, v23
    v_and_b32 v47, 0xffff0000, v23
    v_lshlrev_b32 v48, 16, v24
    v_and_b32 v49, 0xffff0000, v24
    v_lshlrev_b32 v50, 16, v25
    v_and_b32 v51, 0xffff0000, v25
    v_lshlrev_b32 v52, 16, v26
    v_and_b32 v53, 0xffff0000, v26
    v_lshlrev_b32 v54, 16, v27
    v_and_b32 v55, 0xffff0000, v27
    v_lshlrev_b32 v56, 16, v28
    v_and_b32 v57, 0xffff0000, v28
    v_lshlrev_b32 v58, 16, v29
    v_and_b32 v59, 0xffff0000, v29
    v_mov_b32_dpp v60, v32 row_newbcast:0 row_mask:0xf bank_mask:0xf
    v_pk_add_f32 v[66:67], v[32:33], v[60:61] op_sel_hi:[1,0] neg_lo:[0,1] neg_hi:[0,1]
    v_pk_add_f32 v[62:63], v[62:63], v[66:67]
    v_pk_fma_f32 v[64:65], v[66:67], v[66:67], v[64:65]
    v_pk_add_f32 v[66:67], v[34:35], v[60:61] op_sel_hi:[1,0] neg_lo:[0,1] neg_hi:[0,1]
    v_pk_add_f32 v[62:63], v[62:63], v[66:67]
    v_pk_fma_f32 v[64:65], v[66:67], v[66:67], v[64:65]
    v_pk_add_f32 v[66:67], v[36:37], v[60:61] op_sel_hi:[1,0] neg_lo:[0,1] neg_hi:[0,1]
    v_pk_add_f32 v[62:63], v[62:63], v[66:67]
    v_pk_fma_f32 v[64:65], v[66:67], v[66:67], v[64:65]
    v_pk_add_f32 v[66:67], v[38:39], v[60:61] op_sel_hi:[1,0] neg_lo:[0,1] neg_hi:[0,1]
    v_pk_add_f32 v[62:63], v[62:63], v[66:67]
    v_pk_fma_f32 v[64:65], v[66:67], v[66:67], v[64:65]
    v_pk_add_f32 v[66:67], v[40:41], v[60:61] op_sel_hi:[1,0] neg_lo:[0,1] neg_hi:[0,1]
    v_pk_add_f32 v[62:63], v[62:63], v[66:67]
    v_pk_fma_f32 v[64:65], v[66:67], v[66:67], v[64:65]
    v_pk_add_f32 v[66:67], v[42:43], v[60:61] op_sel_hi:[1,0] neg_lo:[0,1] neg_hi:[0,1]
    v_pk_add_f32 v[62:63], v[62:63], v[66:67]
    v_pk_fma_f32 v[64:65], v[66:67], v[66:67], v[64:65]
    v_pk_add_f32 v[66:67], v[44:45], v[60:61] op_sel_hi:[1,0] neg_lo:[0,1] neg_hi:[0,1]
    v_pk_add_f32 v[62:63], v[62:63], v[66:67]
    v_pk_fma_f32 v[64:65], v[66:67], v[66:67], v[64:65]
    v_pk_add_f32 v[66:67], v[46:47], v[60:61] op_sel_hi:[1,0] neg_lo:[0,1] neg_hi:[0,1]
    v_pk_add_f32 v[62:63], v[62:63], v[66:67]
    v_pk_fma_f32 v[64:65], v[66:67], v[66:67], v[64:65]
    v_pk_add_f32 v[66:67], v[48:49], v[60:61] op_sel_hi:[1,0] neg_lo:[0,1] neg_hi:[0,1]
    v_pk_add_f32 v[62:63], v[62:63], v[66:67]
    v_pk_fma_f32 v[64:65], v[66:67], v[66:67], v[64:65]
    v_pk_add_f32 v[66:67], v[50:51], v[60:61] op_sel_hi:[1,0] neg_lo:[0,1] neg_hi:[0,1]
    v_pk_add_f32 v[62:63], v[62:63], v[66:67]
    v_pk_fma_f32 v[64:65], v[66:67], v[66:67], v[64:65]
    v_pk_add_f32 v[66:67], v[52:53], v[60:61] op_sel_hi:[1,0] neg_lo:[0,1] neg_hi:[0,1]
    v_pk_add_f32 v[62:63], v[62:63], v[66:67]
    v_pk_fma_f32 v[64:65], v[66:67], v[66:67], v[64:65]
    v_pk_add_f32 v[66:67], v[54:55], v[60:61] op_sel_hi:[1,0] neg_lo:[0,1] neg_hi:[0,1]
    v_pk_add_f32 v[62:63], v[62:63], v[66:67]
    v_pk_fma_f32 v[64:65], v[66:67], v[66:67], v[64:65]
    v_pk_add_f32 v[66:67], v[56:57], v[60:61] op_sel_hi:[1,0] neg_lo:[0,1] neg_hi:[0,1]
    v_pk_add_f32 v[62:63], v[62:63], v[66:67]
    v_pk_fma_f32 v[64:65], v[66:67], v[66:67], v[64:65]
    v_pk_add_f32 v[66:67], v[58:59], v[60:61] op_sel_hi:[1,0] neg_lo:[0,1] neg_hi:[0,1]
    v_pk_add_f32 v[62:63], v[62:63], v[66:67]
    v_pk_fma_f32 v[64:65], v[66:67], v[66:67], v[64:65]
    v_add_f32 v62, v62, v63
    v_add_f32 v64, v64, v65
    s_nop 0
    v_add_f32_dpp v62, v62, v62 quad_perm:[1,0,3,2] row_mask:0xf bank_mask:0xf
    v_add_f32_dpp v64, v64, v64 quad_perm:[1,0,3,2] row_mask:0xf bank_mask:0xf
    s_nop 0
    v_add_f32_dpp v62, v62, v62 quad_perm:[2,3,0,1] row_mask:0xf bank_mask:0xf
    v_add_f32_dpp v64, v64, v64 quad_perm:[2,3,0,1] row_mask:0xf bank_mask:0xf
    s_nop 0
    v_add_f32_dpp v62, v62, v62 row_half_mirror row_mask:0xf bank_mask:0xf
    v_add_f32_dpp v64, v64, v64 row_half_mirror row_mask:0xf bank_mask:0xf
    s_nop 0
    v_add_f32_dpp v62, v62, v62 row_mirror row_mask:0xf bank_mask:0xf
    v_add_f32_dpp v64, v64, v64 row_mirror row_mask:0xf bank_mask:0xf
    s_mov_b32 s61, 0x3b124925
    s_mov_b32 s62, 0x3727c5ac
    v_mul_f32 v62, s61, v62
    v_mul_f32 v64, s61, v64
    v_fma_f32 v64, -v62, v62, v64
    v_max_f32 v64, 0, v64
    v_add_f32 v62, v60, v62
    v_cvt_pk_bf16_f32 v62, v62, v62
    v_and_b32 v62, 0xffff0000, v62
    v_cvt_pk_bf16_f32 v64, v64, v64
    v_and_b32 v64, 0xffff0000, v64
    v_add_f32 v64, s62, v64
    v_cvt_pk_bf16_f32 v64, v64, v64
    v_and_b32 v64, 0xffff0000, v64
    v_sqrt_f32 v64, v64
    s_nop 0
    v_cvt_pk_bf16_f32 v64, v64, v64
    v_and_b32 v64, 0xffff0000, v64
    v_rcp_f32 v64, v64
    v_pk_add_f32 v[32:33], v[32:33], v[62:63] op_sel_hi:[1,0] neg_lo:[0,1] neg_hi:[0,1]
    v_cvt_pk_bf16_f32 v66, v32, v33
    v_lshlrev_b32 v32, 16, v66
    v_and_b32 v33, 0xffff0000, v66
    v_pk_mul_f32 v[32:33], v[32:33], v[64:65] op_sel_hi:[1,0]
    v_cvt_pk_bf16_f32 v16, v32, v33
    v_pk_add_f32 v[34:35], v[34:35], v[62:63] op_sel_hi:[1,0] neg_lo:[0,1] neg_hi:[0,1]
    v_cvt_pk_bf16_f32 v66, v34, v35
    v_lshlrev_b32 v34, 16, v66
    v_and_b32 v35, 0xffff0000, v66
    v_pk_mul_f32 v[34:35], v[34:35], v[64:65] op_sel_hi:[1,0]
    v_cvt_pk_bf16_f32 v17, v34, v35
    v_pk_add_f32 v[36:37], v[36:37], v[62:63] op_sel_hi:[1,0] neg_lo:[0,1] neg_hi:[0,1]
    v_cvt_pk_bf16_f32 v66, v36, v37
    v_lshlrev_b32 v36, 16, v66
    v_and_b32 v37, 0xffff0000, v66
    v_pk_mul_f32 v[36:37], v[36:37], v[64:65] op_sel_hi:[1,0]
    v_cvt_pk_bf16_f32 v18, v36, v37
    v_pk_add_f32 v[38:39], v[38:39], v[62:63] op_sel_hi:[1,0] neg_lo:[0,1] neg_hi:[0,1]
    v_cvt_pk_bf16_f32 v66, v38, v39
    v_lshlrev_b32 v38, 16, v66
    v_and_b32 v39, 0xffff0000, v66
    v_pk_mul_f32 v[38:39], v[38:39], v[64:65] op_sel_hi:[1,0]
    v_cvt_pk_bf16_f32 v19, v38, v39
    v_pk_add_f32 v[40:41], v[40:41], v[62:63] op_sel_hi:[1,0] neg_lo:[0,1] neg_hi:[0,1]
    v_cvt_pk_bf16_f32 v66, v40, v41
    v_lshlrev_b32 v40, 16, v66
    v_and_b32 v41, 0xffff0000, v66
    v_pk_mul_f32 v[40:41], v[40:41], v[64:65] op_sel_hi:[1,0]
    v_cvt_pk_bf16_f32 v20, v40, v41
    v_pk_add_f32 v[42:43], v[42:43], v[62:63] op_sel_hi:[1,0] neg_lo:[0,1] neg_hi:[0,1]
    v_cvt_pk_bf16_f32 v66, v42, v43
    v_lshlrev_b32 v42, 16, v66
    v_and_b32 v43, 0xffff0000, v66
    v_pk_mul_f32 v[42:43], v[42:43], v[64:65] op_sel_hi:[1,0]
    v_cvt_pk_bf16_f32 v21, v42, v43
    v_pk_add_f32 v[44:45], v[44:45], v[62:63] op_sel_hi:[1,0] neg_lo:[0,1] neg_hi:[0,1]
    v_cvt_pk_bf16_f32 v66, v44, v45
    v_lshlrev_b32 v44, 16, v66
    v_and_b32 v45, 0xffff0000, v66
    v_pk_mul_f32 v[44:45], v[44:45], v[64:65] op_sel_hi:[1,0]
    v_cvt_pk_bf16_f32 v22, v44, v45
    v_pk_add_f32 v[46:47], v[46:47], v[62:63] op_sel_hi:[1,0] neg_lo:[0,1] neg_hi:[0,1]
    v_cvt_pk_bf16_f32 v66, v46, v47
    v_lshlrev_b32 v46, 16, v66
    v_and_b32 v47, 0xffff0000, v66
    v_pk_mul_f32 v[46:47], v[46:47], v[64:65] op_sel_hi:[1,0]
    v_cvt_pk_bf16_f32 v23, v46, v47
    v_pk_add_f32 v[48:49], v[48:49], v[62:63] op_sel_hi:[1,0] neg_lo:[0,1] neg_hi:[0,1]
    v_cvt_pk_bf16_f32 v66, v48, v49
    v_lshlrev_b32 v48, 16, v66
    v_and_b32 v49, 0xffff0000, v66
    v_pk_mul_f32 v[48:49], v[48:49], v[64:65] op_sel_hi:[1,0]
    v_cvt_pk_bf16_f32 v24, v48, v49
    v_pk_add_f32 v[50:51], v[50:51], v[62:63] op_sel_hi:[1,0] neg_lo:[0,1] neg_hi:[0,1]
    v_cvt_pk_bf16_f32 v66, v50, v51
    v_lshlrev_b32 v50, 16, v66
    v_and_b32 v51, 0xffff0000, v66
    v_pk_mul_f32 v[50:51], v[50:51], v[64:65] op_sel_hi:[1,0]
    v_cvt_pk_bf16_f32 v25, v50, v51
    v_pk_add_f32 v[52:53], v[52:53], v[62:63] op_sel_hi:[1,0] neg_lo:[0,1] neg_hi:[0,1]
    v_cvt_pk_bf16_f32 v66, v52, v53
    v_lshlrev_b32 v52, 16, v66
    v_and_b32 v53, 0xffff0000, v66
    v_pk_mul_f32 v[52:53], v[52:53], v[64:65] op_sel_hi:[1,0]
    v_cvt_pk_bf16_f32 v26, v52, v53
    v_pk_add_f32 v[54:55], v[54:55], v[62:63] op_sel_hi:[1,0] neg_lo:[0,1] neg_hi:[0,1]
    v_cvt_pk_bf16_f32 v66, v54, v55
    v_lshlrev_b32 v54, 16, v66
    v_and_b32 v55, 0xffff0000, v66
    v_pk_mul_f32 v[54:55], v[54:55], v[64:65] op_sel_hi:[1,0]
    v_cvt_pk_bf16_f32 v27, v54, v55
    v_pk_add_f32 v[56:57], v[56:57], v[62:63] op_sel_hi:[1,0] neg_lo:[0,1] neg_hi:[0,1]
    v_cvt_pk_bf16_f32 v66, v56, v57
    v_lshlrev_b32 v56, 16, v66
    v_and_b32 v57, 0xffff0000, v66
    v_pk_mul_f32 v[56:57], v[56:57], v[64:65] op_sel_hi:[1,0]
    v_cvt_pk_bf16_f32 v28, v56, v57
    v_pk_add_f32 v[58:59], v[58:59], v[62:63] op_sel_hi:[1,0] neg_lo:[0,1] neg_hi:[0,1]
    v_cvt_pk_bf16_f32 v66, v58, v59
    v_lshlrev_b32 v58, 16, v66
    v_and_b32 v59, 0xffff0000, v66
    v_pk_mul_f32 v[58:59], v[58:59], v[64:65] op_sel_hi:[1,0]
    v_cvt_pk_bf16_f32 v29, v58, v59
    ds_write_b64 v6, v[16:17] offset:4096
    ds_write_b64 v6, v[18:19] offset:4104
    ds_write_b64 v6, v[20:21] offset:4112
    ds_write_b64 v6, v[22:23] offset:4120
    ds_write_b64 v6, v[24:25] offset:4128
    ds_write_b64 v6, v[26:27] offset:4136
    ds_write_b64 v6, v[28:29] offset:4144
    v_mul_u32_u24 v2, 896, v8
    v_lshl_add_u32 v2, v3, 4, v2
    s_mul_i32 s53, s47, 448
    v_add_u32 v2, s53, v2
    v_bfe_u32 v4, v1, 2, 2
    v_lshlrev_b32 v4, 6, v4
    v_lshl_add_u32 v4, v8, 3, v4
    v_lshl_add_u32 v4, v3, 9, v4
    s_waitcnt lgkmcnt(0)
    ds_read_b128 v[32:35], v2 offset:4096
    ds_read_b128 v[36:39], v2 offset:4160
    ds_read_b128 v[40:43], v2 offset:4224
    ds_read_b128 v[44:47], v2 offset:4288
    ds_read_b128 v[48:51], v2 offset:4352
    ds_read_b128 v[52:55], v2 offset:4416
    ds_read_b128 v[56:59], v2 offset:4480
    s_add_u32 s46, s46, 1
    v_mov_b32 v7, 0
    s_mov_b32 s60, 0
    s_branch L_pqf_13
L_pq_14:
    s_sleep 1
L_pqf_13:
    ds_read_b32 v12, v7 offset:12
    s_waitcnt lgkmcnt(0)
    v_cmp_ne_u32 vcc, 3, v12
    s_cbranch_vccz L_out_15
    s_add_u32 s60, s60, 1
    s_cmp_le_u32 s60, 200000
    s_cbranch_scc1 L_pq_14
L_out_15:
    ds_read_b64_tr_b16 v[64:65], v4 offset:20480
    ds_read_b64_tr_b16 v[66:67], v4 offset:20736
    ds_read_b64_tr_b16 v[68:69], v4 offset:20512
    ds_read_b64_tr_b16 v[70:71], v4 offset:20768
    ds_read_b64_tr_b16 v[72:73], v4 offset:22528
    ds_read_b64_tr_b16 v[74:75], v4 offset:22784
    ds_read_b64_tr_b16 v[76:77], v4 offset:22560
    ds_read_b64_tr_b16 v[78:79], v4 offset:22816
    ds_read_b64_tr_b16 v[80:81], v4 offset:24576
    ds_read_b64_tr_b16 v[82:83], v4 offset:24832
    ds_read_b64_tr_b16 v[84:85], v4 offset:24608
    ds_read_b64_tr_b16 v[86:87], v4 offset:24864
    ds_read_b64_tr_b16 v[88:89], v4 offset:26624
    ds_read_b64_tr_b16 v[90:91], v4 offset:26880
    ds_read_b64_tr_b16 v[92:93], v4 offset:26656
    ds_read_b64_tr_b16 v[94:95], v4 offset:26912
    ds_read_b64_tr_b16 v[96:97], v4 offset:28672
    ds_read_b64_tr_b16 v[98:99], v4 offset:28928
    ds_read_b64_tr_b16 v[100:101], v4 offset:28704
    ds_read_b64_tr_b16 v[102:103], v4 offset:28960
    ds_read_b64_tr_b16 v[104:105], v4 offset:30720
    ds_read_b64_tr_b16 v[106:107], v4 offset:30976
    ds_read_b64_tr_b16 v[108:109], v4 offset:30752
    ds_read_b64_tr_b16 v[110:111], v4 offset:31008
    ds_read_b64_tr_b16 v[112:113], v4 offset:32768
    ds_read_b64_tr_b16 v[114:115], v4 offset:33024
    ds_read_b64_tr_b16 v[116:117], v4 offset:32800
    ds_read_b64_tr_b16 v[118:119], v4 offset:33056
    v_mov_b32 v31, s46
    ds_write_b32 v7, v31 offset:24
    s_waitcnt lgkmcnt(0)
    v_mfma_f32_16x16x32_bf16 v[16:19], v[64:67], v[32:35], 0
    v_mfma_f32_16x16x32_bf16 v[20:23], v[68:71], v[32:35], 0
    v_mfma_f32_16x16x32_bf16 v[16:19], v[72:75], v[36:39], v[16:19]
    v_mfma_f32_16x16x32_bf16 v[20:23], v[76:79], v[36:39], v[20:23]
    v_mfma_f32_16x16x32_bf16 v[16:19], v[80:83], v[40:43], v[16:19]
    v_mfma_f32_16x16x32_bf16 v[20:23], v[84:87], v[40:43], v[20:23]
    v_mfma_f32_16x16x32_bf16 v[16:19], v[88:91], v[44:47], v[16:19]
    v_mfma_f32_16x16x32_bf16 v[20:23], v[92:95], v[44:47], v[20:23]
    v_mfma_f32_16x16x32_bf16 v[16:19], v[96:99], v[48:51], v[16:19]
    v_mfma_f32_16x16x32_bf16 v[20:23], v[100:103], v[48:51], v[20:23]
    v_mfma_f32_16x16x32_bf16 v[16:19], v[104:107], v[52:55], v[16:19]
    v_mfma_f32_16x16x32_bf16 v[20:23], v[108:111], v[52:55], v[20:23]
    v_mfma_f32_16x16x32_bf16 v[16:19], v[112:115], v[56:59], v[16:19]
    v_mfma_f32_16x16x32_bf16 v[20:23], v[116:119], v[56:59], v[20:23]
    v_lshlrev_b32 v2, 8, v8
    v_lshl_add_u32 v2, v3, 5, v2
    v_bfe_u32 v4, v1, 3, 1
    v_lshl_add_u32 v2, v4, 7, v2
    v_bfe_u32 v5, v1, 2, 1
    v_lshl_add_u32 v2, v5, 4, v2
    v_cmp_eq_u32 s[62:63], 1, v4
    v_cmp_eq_u32 vcc, 1, v5
    v_mov_b32 v25, s46
    v_mov_b32 v27, s46
    v_cndmask_b32 v24, v16, v18, vcc
    v_cndmask_b32 v26, v17, v19, vcc
    v_cndmask_b32 v28, v20, v22, vcc
    v_cndmask_b32 v29, v21, v23, vcc
    v_cndmask_b32 v24, v24, v28, s[62:63]
    v_cndmask_b32 v26, v26, v29, s[62:63]
    v_and_b32 v24, -8, v24
    v_or_b32 v24, s45, v24
    buffer_store_dwordx4 v[24:27], v2, s[48:51], s44 offen sc1
    s_lshl_b32 s53, s31, 15
    s_lshl_b32 s54, s32, 8
    s_add_u32 s53, s53, s54
    s_add_u32 s36, s53, 65536
    s_add_u32 s37, s36, 8192
    s_add_u32 s38, s36, 16384
    s_add_u32 s39, s36, 24576
    v_and_b32 v5, 7, v1
    v_lshlrev_b32 v11, 2, v1
    s_mov_b32 s60, 0
    s_branch L_qf_16
L_q_17:
    s_sleep 6
L_qf_16:
    buffer_load_dwordx4 v[32:35], v10, s[48:51], s36 offen offset:0 sc1
    buffer_load_dwordx4 v[36:39], v10, s[48:51], s36 offen offset:1024 sc1
    buffer_load_dwordx4 v[40:43], v10, s[48:51], s37 offen offset:0 sc1
    buffer_load_dwordx4 v[44:47], v10, s[48:51], s37 offen offset:1024 sc1
    buffer_load_dwordx4 v[48:51], v10, s[48:51], s38 offen offset:0 sc1
    buffer_load_dwordx4 v[52:55], v10, s[48:51], s38 offen offset:1024 sc1
    buffer_load_dwordx4 v[56:59], v10, s[48:51], s39 offen offset:0 sc1
    buffer_load_dwordx4 v[60:63], v10, s[48:51], s39 offen offset:1024 sc1
    s_waitcnt vmcnt(0)
    v_mov_b32 v6, 0
    v_xor_b32 v33, s46, v33
    v_xor_b32 v35, s46, v35
    v_or3_b32 v6, v6, v33, v35
    v_xor_b32 v37, s46, v37
    v_xor_b32 v39, s46, v39
    v_or3_b32 v6, v6, v37, v39
    v_xor_b32 v41, s46, v41
    v_xor_b32 v43, s46, v43
    v_or3_b32 v6, v6, v41, v43
    v_xor_b32 v45, s46, v45
    v_xor_b32 v47, s46, v47
    v_or3_b32 v6, v6, v45, v47
    v_xor_b32 v49, s46, v49
    v_xor_b32 v51, s46, v51
    v_or3_b32 v6, v6, v49, v51
    v_xor_b32 v53, s46, v53
    v_xor_b32 v55, s46, v55
    v_or3_b32 v6, v6, v53, v55
    v_xor_b32 v57, s46, v57
    v_xor_b32 v59, s46, v59
    v_or3_b32 v6, v6, v57, v59
    v_xor_b32 v61, s46, v61
    v_xor_b32 v63, s46, v63
    v_or3_b32 v6, v6, v61, v63
    v_cmp_ne_u32 vcc, 0, v6
    s_cbranch_vccz L_out_18
    s_add_u32 s60, s60, 1
    s_cmp_le_u32 s60, 200000
    s_cbranch_scc1 L_q_17
L_out_18:
    v_xor_b32 v30, s45, v32
    v_xor_b32 v31, s45, v36
    v_or_b32 v30, v30, v31
    v_xor_b32 v31, s45, v40
    v_or_b32 v30, v30, v31
    v_xor_b32 v31, s45, v44
    v_or_b32 v30, v30, v31
    v_xor_b32 v31, s45, v48
    v_or_b32 v30, v30, v31
    v_xor_b32 v31, s45, v52
    v_or_b32 v30, v30, v31
    v_xor_b32 v31, s45, v56
    v_or_b32 v30, v30, v31
    v_xor_b32 v31, s45, v60
    v_or_b32 v30, v30, v31
    v_and_b32 v32, -8, v32
    v_and_b32 v36, -8, v36
    v_and_b32 v40, -8, v40
    v_and_b32 v44, -8, v44
    v_and_b32 v48, -8, v48
    v_and_b32 v52, -8, v52
    v_and_b32 v56, -8, v56
    v_and_b32 v60, -8, v60
    v_add_f32 v32, v32, v36
    v_add_f32 v34, v34, v38
    v_cvt_pk_bf16_f32 v32, v32, v34
    ds_write_b32 v11, v32 offset:256
    v_add_f32 v40, v40, v44
    v_add_f32 v42, v42, v46
    v_cvt_pk_bf16_f32 v40, v40, v42
    ds_write_b32 v11, v40 offset:512
    v_add_f32 v48, v48, v52
    v_add_f32 v50, v50, v54
    v_cvt_pk_bf16_f32 v48, v48, v50
    ds_write_b32 v11, v48 offset:768
    v_add_f32 v56, v56, v60
    v_add_f32 v58, v58, v62
    v_cvt_pk_bf16_f32 v56, v56, v58
    ds_write_b32 v11, v56 offset:1024
    v_and_b32 v30, 7, v30
    v_cmp_ne_u32 vcc, 0, v30
    s_cmp_eq_u64 vcc, 0
    s_cselect_b32 s45, 2, 1
    v_mov_b32 v6, s45
    s_waitcnt lgkmcnt(0)
    ds_write_b32 v7, v6 offset:0
    s_mov_b32 s60, 0
    s_branch L_scf_19
L_sc_20:
    s_sleep 2
L_scf_19:
    ds_read_b32 v6, v7 offset:4
    s_waitcnt lgkmcnt(0)
    v_cmp_ne_u32 vcc, 8, v6
    s_cbranch_vccz L_out_21
    s_add_u32 s60, s60, 1
    s_cmp_le_u32 s60, 200000
    s_cbranch_scc1 L_sc_20
L_out_21:
    v_and_b32 v2, 15, v1
    v_lshlrev_b32 v2, 2, v2
    ds_read_b32 v16, v2 offset:64
    ds_read_b32 v17, v2 offset:128
    s_waitcnt lgkmcnt(0)
    v_mov_b32 v18, v16
    s_nop 1
    v_max_f32_dpp v18, v18, v18 quad_perm:[1,0,3,2] row_mask:0xf bank_mask:0xf
    s_nop 1
    v_max_f32_dpp v18, v18, v18 quad_perm:[2,3,0,1] row_mask:0xf bank_mask:0xf
    s_nop 1
    v_max_f32_dpp v18, v18, v18 row_half_mirror row_mask:0xf bank_mask:0xf
    v_sub_f32 v19, v16, v18
    v_exp_f32 v16, v19
    v_and_b32 v3, 8, v1
    v_mul_f32 v20, v16, v17
    v_mov_b32 v17, v16
    v_lshlrev_b32 v2, 1, v2
    ds_write_b64 v2, v[16:17] offset:7680
    s_nop 1
    v_add_f32_dpp v20, v20, v20 quad_perm:[1,0,3,2] row_mask:0xf bank_mask:0xf
    s_nop 1
    v_add_f32_dpp v20, v20, v20 quad_perm:[2,3,0,1] row_mask:0xf bank_mask:0xf
    s_nop 1
    v_add_f32_dpp v20, v20, v20 row_half_mirror row_mask:0xf bank_mask:0xf
    v_mov_b32 v19, s46
    v_mov_b32 v21, s46
    v_lshlrev_b32 v3, 1, v3
    s_mov_b64 exec, 0x101
    s_cmp_eq_u32 s45, 2
    s_cbranch_scc1 L_stl
    buffer_store_dwordx4 v[18:21], v3, s[48:51], s56 offen sc1
    s_branch L_stg
L_stl:
    buffer_store_dwordx4 v[18:21], v3, s[48:51], s56 offen
L_stg:
    s_mov_b64 exec, -1
    s_cmp_eq_u32 s33, 7
    s_cbranch_scc0 L_q_w
    s_waitcnt lgkmcnt(0)
    s_barrier
    s_branch L_q_done
L_q_w:
    v_lshlrev_b32 v3, 5, v1
    v_lshlrev_b32 v2, 3, v1
    s_lshl1_add_u32 s53, s31, s47
    s_lshl_b32 s53, s53, 9
    s_and_b32 s54, s32, 1
    s_lshl4_add_u32 s53, s54, s53
    s_add_u32 s53, s53, 8192
    s_mov_b64 exec, 0xffff
    s_mov_b32 s60, 0
    buffer_load_dwordx4 v[24:27], v3, s[48:51], s53 offen sc1
    s_waitcnt lgkmcnt(0)
    s_barrier
    s_branch L_st_chk
L_st:
    s_sleep 1
    buffer_load_dwordx4 v[24:27], v3, s[48:51], s53 offen sc1
L_st_chk:
    s_waitcnt vmcnt(0)
    v_xor_b32 v25, s46, v25
    v_xor_b32 v27, s46, v27
    v_or_b32 v6, v25, v27
    v_cmp_ne_u32 vcc, 0, v6
    s_cbranch_vccz L_out_22
    s_add_u32 s60, s60, 1
    s_cmp_le_u32 s60, 200000
    s_cbranch_scc1 L_st
L_out_22:
    v_mov_b32 v22, v24
    s_nop 1
    v_max_f32_dpp v22, v22, v22 quad_perm:[1,0,3,2] row_mask:0xf bank_mask:0xf
    s_nop 1
    v_max_f32_dpp v22, v22, v22 quad_perm:[2,3,0,1] row_mask:0xf bank_mask:0xf
    s_nop 1
    v_max_f32_dpp v22, v22, v22 row_half_mirror row_mask:0xf bank_mask:0xf
    v_sub_f32 v24, v24, v22
    v_exp_f32 v16, v24
    s_nop 0
    v_mul_f32 v24, v16, v26
    s_nop 1
    v_add_f32_dpp v24, v24, v24 quad_perm:[1,0,3,2] row_mask:0xf bank_mask:0xf
    s_nop 1
    v_add_f32_dpp v24, v24, v24 quad_perm:[2,3,0,1] row_mask:0xf bank_mask:0xf
    s_nop 1
    v_add_f32_dpp v24, v24, v24 row_half_mirror row_mask:0xf bank_mask:0xf
    v_rcp_f32 v24, v24
    s_nop 0
    v_mul_f32 v16, v16, v24
    v_min_u32 v16, -2, v16
    v_mov_b32 v17, v16
    ds_write_b64 v2, v[16:17] offset:7808
L_q_done:
    s_waitcnt lgkmcnt(0)
    s_endpgm
L_end:
    s_endpgm
.section .rodata,"a"
.p2align 6
.amdhsa_kernel sequential_preLN__sliding_block_cached__mixer_token_mlp__decode_kernel
  .amdhsa_next_free_vgpr 168
  .amdhsa_next_free_sgpr 96
  .amdhsa_accum_offset 168
  .amdhsa_group_segment_fixed_size 0
  .amdhsa_kernarg_size 104
  .amdhsa_user_sgpr_count 2
  .amdhsa_user_sgpr_kernarg_segment_ptr 1
  .amdhsa_system_sgpr_workgroup_id_x 1
  .amdhsa_float_denorm_mode_32 3
.end_amdhsa_kernel
```
